```python
import torch

def _softmax(x, axis=-1):
    return torch.softmax(x, dim=axis)
def _gelu(x):
    return torch.nn.functional.gelu(x, approximate="tanh")
def _silu(x):
    return torch.nn.functional.silu(x)
def _sigmoid(x):
    return torch.sigmoid(x)
def _layernorm(x, axis=-1, eps=1e-5):
    m = x.mean(dim=axis, keepdim=True)
    v = x.var(dim=axis, keepdim=True, unbiased=False)
    return (x - m) / torch.sqrt(v + eps)
def _scatter_add(tgt, idx, src, axis=0):
    return tgt.clone().index_add_(axis, idx, src)
def _segment_sum(src, seg, n):
    out = torch.zeros((n,) + src.shape[1:], dtype=src.dtype)
    return out.index_add_(0, seg, src)
def _pad(x, pw):
    flat = tuple(v for pair in reversed(pw) for v in pair)
    return torch.nn.functional.pad(x, flat)

kernel_name = 'sequential_preLN__grouped_kv_mqa__glu_gated_swiglu__prompt'

def setup_inputs():

    _w = (lambda a: (lambda t: t.to(torch.bfloat16) if t.is_floating_point() else t)(torch.as_tensor(a)))
    def _A_setup():
        B, S, D, H = 1, 2048, 512, 32
        Dh = D // H
        return {
            "x": _w((lambda *s: torch.randn(*s, dtype=torch.bfloat16) * 0.05)(B, S, D)),
            "wq": _w((lambda *s: torch.randn(*s, dtype=torch.bfloat16) * 0.05)(D, H * Dh)),
            "wk": _w((lambda *s: torch.randn(*s, dtype=torch.bfloat16) * 0.05)(D, Dh)),
            "wv": _w((lambda *s: torch.randn(*s, dtype=torch.bfloat16) * 0.05)(D, Dh)),
            "wo": _w((lambda *s: torch.randn(*s, dtype=torch.bfloat16) * 0.05)(H * Dh, D)),
        }
    _A_in = _A_setup()

    def _B_setup():
        B, S, D, F = 1, 2048, 512, 1376
        return {
            "x": _w((lambda *s: torch.randn(*s, dtype=torch.bfloat16) * 0.05)(B, S, D)),
            "w1": _w((lambda *s: torch.randn(*s, dtype=torch.bfloat16) * 0.4)(D, F) * (2.0 / D) ** 0.5),
            "w3": _w((lambda *s: torch.randn(*s, dtype=torch.bfloat16) * 0.4)(D, F) * (2.0 / D) ** 0.5),
            "w2": _w((lambda *s: torch.randn(*s, dtype=torch.bfloat16) * 0.4)(F, D) * (2.0 / F) ** 0.5),
        }
    _B_in = _B_setup()

    return {
        "A_x": _A_in["x"],
        "A_wq": _A_in["wq"],
        "A_wk": _A_in["wk"],
        "A_wv": _A_in["wv"],
        "A_wo": _A_in["wo"],
        "B_x": _B_in["x"],
        "B_w1": _B_in["w1"],
        "B_w3": _B_in["w3"],
        "B_w2": _B_in["w2"],
    }

def reference(A_x, A_wq, A_wk, A_wv, A_wo, B_x, B_w1, B_w3, B_w2):
    def _A_ref(x, wq, wk, wv, wo):
        B, S, D = x.shape
        H = 32
        Dh = D // H
        q = (lambda x, *d: x.permute(*d))((x @ wq).reshape(B, S, H, Dh), 0, 2, 1, 3)
        k = x @ wk
        v = x @ wv
        scores = torch.einsum("bhqd,bkd->bhqk", q, k) * (Dh ** -0.5)
        p = _softmax(scores, axis=-1)
        o = torch.einsum("bhqk,bkd->bhqd", p, v)
        return (lambda x, *d: x.permute(*d))(o, 0, 2, 1, 3).reshape(B, S, H * Dh) @ wo

    def _B_ref(x, w1, w3, w2):
        gate = torch.einsum("bsd,df->bsf", x, w1)
        up = torch.einsum("bsd,df->bsf", x, w3)
        h = _silu(gate) * up
        out = torch.einsum("bsf,fd->bsd", h, w2)
        return out

    x = A_x
    h = x + _A_ref(_layernorm(x, axis=-1), A_wq, A_wk, A_wv, A_wo)
    h2 = h + _B_ref(_layernorm(h, axis=-1), B_w1, B_w3, B_w2)
    return h2
```

```asm
; @launch kernel=k1_kernel grid=(272,1,1) block=(256,1,1) lds=32768
; @launch kernel=k2_kernel grid=(256,1,1) block=(512,1,1) lds=133120
; @launch kernel=k3_kernel grid=(256,1,1) block=(256,1,1) lds=32768
; @launch kernel=k4_kernel grid=(256,1,1) block=(256,1,1) lds=65536
; @launch kernel=k5_kernel grid=(256,1,1) block=(256,1,1) lds=88064
.amdgcn_target "amdgcn-amd-amdhsa--gfx950"
.text
.globl k1_kernel
.p2align 8
.type k1_kernel,@function
k1_kernel:
    s_cmp_ge_u32 s2, 272
    s_cbranch_scc1 L1_end
    s_load_dwordx2 s[8:9], s[0:1], 0
    s_load_dwordx2 s[12:13], s[0:1], 8
    s_load_dwordx2 s[16:17], s[0:1], 16
    s_load_dwordx2 s[24:25], s[0:1], 24
    s_load_dwordx2 s[20:21], s[0:1], 88
    s_and_b32 s4, s2, 15
    s_lshr_b32 s5, s2, 4
    v_and_b32 v1, 63, v0
    v_lshrrev_b32 v2, 6, v0
    v_and_b32 v3, 31, v0
    v_bfe_u32 v4, v0, 5, 1
    s_lshl_b32 s6, s4, 7
    v_lshlrev_b32 v5, 5, v2
    v_add_u32 v5, v5, v3
    v_add_u32 v5, s6, v5
    v_mov_b32 v10, v5
    v_mov_b32 v11, v4
    v_lshlrev_b32 v6, 10, v5
    v_lshl_add_u32 v6, v4, 4, v6
    s_waitcnt lgkmcnt(0)
    s_mov_b32 s10, 2097152
    s_mov_b32 s11, 0x00020000
    s_mov_b32 s14, 524288
    s_mov_b32 s15, 0x00020000
    s_mov_b32 s18, 16384
    s_mov_b32 s19, 0x00020000
    s_mov_b32 s26, 16384
    s_mov_b32 s27, 0x00020000
    s_mov_b32 s22, 16777216
    s_mov_b32 s23, 0x00020000
    buffer_load_dwordx4 v[128:131], v6, s[8:11], 0 offen offset:0
    buffer_load_dwordx4 v[132:135], v6, s[8:11], 0 offen offset:32
    buffer_load_dwordx4 v[136:139], v6, s[8:11], 0 offen offset:64
    buffer_load_dwordx4 v[140:143], v6, s[8:11], 0 offen offset:96
    buffer_load_dwordx4 v[144:147], v6, s[8:11], 0 offen offset:128
    buffer_load_dwordx4 v[148:151], v6, s[8:11], 0 offen offset:160
    buffer_load_dwordx4 v[152:155], v6, s[8:11], 0 offen offset:192
    buffer_load_dwordx4 v[156:159], v6, s[8:11], 0 offen offset:224
    buffer_load_dwordx4 v[160:163], v6, s[8:11], 0 offen offset:256
    buffer_load_dwordx4 v[164:167], v6, s[8:11], 0 offen offset:288
    buffer_load_dwordx4 v[168:171], v6, s[8:11], 0 offen offset:320
    buffer_load_dwordx4 v[172:175], v6, s[8:11], 0 offen offset:352
    buffer_load_dwordx4 v[176:179], v6, s[8:11], 0 offen offset:384
    buffer_load_dwordx4 v[180:183], v6, s[8:11], 0 offen offset:416
    buffer_load_dwordx4 v[184:187], v6, s[8:11], 0 offen offset:448
    buffer_load_dwordx4 v[188:191], v6, s[8:11], 0 offen offset:480
    buffer_load_dwordx4 v[192:195], v6, s[8:11], 0 offen offset:512
    buffer_load_dwordx4 v[196:199], v6, s[8:11], 0 offen offset:544
    buffer_load_dwordx4 v[200:203], v6, s[8:11], 0 offen offset:576
    buffer_load_dwordx4 v[204:207], v6, s[8:11], 0 offen offset:608
    buffer_load_dwordx4 v[208:211], v6, s[8:11], 0 offen offset:640
    buffer_load_dwordx4 v[212:215], v6, s[8:11], 0 offen offset:672
    buffer_load_dwordx4 v[216:219], v6, s[8:11], 0 offen offset:704
    buffer_load_dwordx4 v[220:223], v6, s[8:11], 0 offen offset:736
    buffer_load_dwordx4 v[224:227], v6, s[8:11], 0 offen offset:768
    buffer_load_dwordx4 v[228:231], v6, s[8:11], 0 offen offset:800
    buffer_load_dwordx4 v[232:235], v6, s[8:11], 0 offen offset:832
    buffer_load_dwordx4 v[236:239], v6, s[8:11], 0 offen offset:864
    buffer_load_dwordx4 v[240:243], v6, s[8:11], 0 offen offset:896
    buffer_load_dwordx4 v[244:247], v6, s[8:11], 0 offen offset:928
    buffer_load_dwordx4 v[248:251], v6, s[8:11], 0 offen offset:960
    buffer_load_dwordx4 v[252:255], v6, s[8:11], 0 offen offset:992
    v_lshrrev_b32 v7, 2, v0
    v_and_b32 v8, 3, v0
    v_lshlrev_b32 v9, 4, v0
    s_cmp_eq_u32 s5, 16
    s_nop 3
    s_cbranch_scc1 L1_kv
    v_lshlrev_b32 v12, 10, v7
    v_lshl_add_u32 v12, v8, 4, v12
    s_lshl_b32 s7, s5, 6
    v_add_u32 v12, s7, v12
    buffer_load_dwordx4 v[32:35], v12, s[12:15], 0 offen
    v_add_u32 v12, 0x10000, v12
    buffer_load_dwordx4 v[36:39], v12, s[12:15], 0 offen
    v_add_u32 v12, 0x10000, v12
    buffer_load_dwordx4 v[40:43], v12, s[12:15], 0 offen
    v_add_u32 v12, 0x10000, v12
    buffer_load_dwordx4 v[44:47], v12, s[12:15], 0 offen
    v_add_u32 v12, 0x10000, v12
    buffer_load_dwordx4 v[48:51], v12, s[12:15], 0 offen
    v_add_u32 v12, 0x10000, v12
    buffer_load_dwordx4 v[52:55], v12, s[12:15], 0 offen
    v_add_u32 v12, 0x10000, v12
    buffer_load_dwordx4 v[56:59], v12, s[12:15], 0 offen
    v_add_u32 v12, 0x10000, v12
    buffer_load_dwordx4 v[60:63], v12, s[12:15], 0 offen
    s_nop 3
    s_branch L1_bstore
    s_nop 3
L1_kv:
    v_lshlrev_b32 v12, 5, v7
    v_and_b32 v13, 1, v8
    v_lshl_add_u32 v12, v13, 4, v12
    v_cmp_gt_u32 vcc, 2, v8
    s_nop 3
    s_and_saveexec_b64 s[28:29], vcc
    s_mov_b32 s7, 0
    buffer_load_dwordx4 v[32:35], v12, s[16:19], s7 offen
    s_mov_b32 s7, 2048
    buffer_load_dwordx4 v[36:39], v12, s[16:19], s7 offen
    s_mov_b32 s7, 4096
    buffer_load_dwordx4 v[40:43], v12, s[16:19], s7 offen
    s_mov_b32 s7, 6144
    buffer_load_dwordx4 v[44:47], v12, s[16:19], s7 offen
    s_mov_b32 s7, 8192
    buffer_load_dwordx4 v[48:51], v12, s[16:19], s7 offen
    s_mov_b32 s7, 10240
    buffer_load_dwordx4 v[52:55], v12, s[16:19], s7 offen
    s_mov_b32 s7, 12288
    buffer_load_dwordx4 v[56:59], v12, s[16:19], s7 offen
    s_mov_b32 s7, 14336
    buffer_load_dwordx4 v[60:63], v12, s[16:19], s7 offen
    s_andn2_b64 exec, s[28:29], exec
    s_mov_b32 s7, 0
    buffer_load_dwordx4 v[32:35], v12, s[24:27], s7 offen
    s_mov_b32 s7, 2048
    buffer_load_dwordx4 v[36:39], v12, s[24:27], s7 offen
    s_mov_b32 s7, 4096
    buffer_load_dwordx4 v[40:43], v12, s[24:27], s7 offen
    s_mov_b32 s7, 6144
    buffer_load_dwordx4 v[44:47], v12, s[24:27], s7 offen
    s_mov_b32 s7, 8192
    buffer_load_dwordx4 v[48:51], v12, s[24:27], s7 offen
    s_mov_b32 s7, 10240
    buffer_load_dwordx4 v[52:55], v12, s[24:27], s7 offen
    s_mov_b32 s7, 12288
    buffer_load_dwordx4 v[56:59], v12, s[24:27], s7 offen
    s_mov_b32 s7, 14336
    buffer_load_dwordx4 v[60:63], v12, s[24:27], s7 offen
    s_mov_b64 exec, s[28:29]
L1_bstore:
    s_waitcnt vmcnt(7)
    ds_write_b128 v9, v[32:35] offset:0
    s_waitcnt vmcnt(6)
    ds_write_b128 v9, v[36:39] offset:4096
    s_waitcnt vmcnt(5)
    ds_write_b128 v9, v[40:43] offset:8192
    s_waitcnt vmcnt(4)
    ds_write_b128 v9, v[44:47] offset:12288
    s_waitcnt vmcnt(3)
    ds_write_b128 v9, v[48:51] offset:16384
    s_waitcnt vmcnt(2)
    ds_write_b128 v9, v[52:55] offset:20480
    s_waitcnt vmcnt(1)
    ds_write_b128 v9, v[56:59] offset:24576
    s_waitcnt vmcnt(0)
    ds_write_b128 v9, v[60:63] offset:28672
    s_waitcnt vmcnt(0)
    s_mov_b32 s30, 0x3f803f80
    v_mov_b32 v2, 0
    v_mov_b32 v6, 0
    v_mov_b32 v3, 0
    v_mov_b32 v7, 0
    v_mov_b32 v4, 0
    v_mov_b32 v8, 0
    v_mov_b32 v5, 0
    v_mov_b32 v9, 0
    v_dot2_f32_bf16 v2, v128, s30, v2
    v_dot2_f32_bf16 v6, v128, v128, v6
    v_dot2_f32_bf16 v3, v129, s30, v3
    v_dot2_f32_bf16 v7, v129, v129, v7
    v_dot2_f32_bf16 v4, v130, s30, v4
    v_dot2_f32_bf16 v8, v130, v130, v8
    v_dot2_f32_bf16 v5, v131, s30, v5
    v_dot2_f32_bf16 v9, v131, v131, v9
    v_dot2_f32_bf16 v2, v132, s30, v2
    v_dot2_f32_bf16 v6, v132, v132, v6
    v_dot2_f32_bf16 v3, v133, s30, v3
    v_dot2_f32_bf16 v7, v133, v133, v7
    v_dot2_f32_bf16 v4, v134, s30, v4
    v_dot2_f32_bf16 v8, v134, v134, v8
    v_dot2_f32_bf16 v5, v135, s30, v5
    v_dot2_f32_bf16 v9, v135, v135, v9
    v_dot2_f32_bf16 v2, v136, s30, v2
    v_dot2_f32_bf16 v6, v136, v136, v6
    v_dot2_f32_bf16 v3, v137, s30, v3
    v_dot2_f32_bf16 v7, v137, v137, v7
    v_dot2_f32_bf16 v4, v138, s30, v4
    v_dot2_f32_bf16 v8, v138, v138, v8
    v_dot2_f32_bf16 v5, v139, s30, v5
    v_dot2_f32_bf16 v9, v139, v139, v9
    v_dot2_f32_bf16 v2, v140, s30, v2
    v_dot2_f32_bf16 v6, v140, v140, v6
    v_dot2_f32_bf16 v3, v141, s30, v3
    v_dot2_f32_bf16 v7, v141, v141, v7
    v_dot2_f32_bf16 v4, v142, s30, v4
    v_dot2_f32_bf16 v8, v142, v142, v8
    v_dot2_f32_bf16 v5, v143, s30, v5
    v_dot2_f32_bf16 v9, v143, v143, v9
    v_dot2_f32_bf16 v2, v144, s30, v2
    v_dot2_f32_bf16 v6, v144, v144, v6
    v_dot2_f32_bf16 v3, v145, s30, v3
    v_dot2_f32_bf16 v7, v145, v145, v7
    v_dot2_f32_bf16 v4, v146, s30, v4
    v_dot2_f32_bf16 v8, v146, v146, v8
    v_dot2_f32_bf16 v5, v147, s30, v5
    v_dot2_f32_bf16 v9, v147, v147, v9
    v_dot2_f32_bf16 v2, v148, s30, v2
    v_dot2_f32_bf16 v6, v148, v148, v6
    v_dot2_f32_bf16 v3, v149, s30, v3
    v_dot2_f32_bf16 v7, v149, v149, v7
    v_dot2_f32_bf16 v4, v150, s30, v4
    v_dot2_f32_bf16 v8, v150, v150, v8
    v_dot2_f32_bf16 v5, v151, s30, v5
    v_dot2_f32_bf16 v9, v151, v151, v9
    v_dot2_f32_bf16 v2, v152, s30, v2
    v_dot2_f32_bf16 v6, v152, v152, v6
    v_dot2_f32_bf16 v3, v153, s30, v3
    v_dot2_f32_bf16 v7, v153, v153, v7
    v_dot2_f32_bf16 v4, v154, s30, v4
    v_dot2_f32_bf16 v8, v154, v154, v8
    v_dot2_f32_bf16 v5, v155, s30, v5
    v_dot2_f32_bf16 v9, v155, v155, v9
    v_dot2_f32_bf16 v2, v156, s30, v2
    v_dot2_f32_bf16 v6, v156, v156, v6
    v_dot2_f32_bf16 v3, v157, s30, v3
    v_dot2_f32_bf16 v7, v157, v157, v7
    v_dot2_f32_bf16 v4, v158, s30, v4
    v_dot2_f32_bf16 v8, v158, v158, v8
    v_dot2_f32_bf16 v5, v159, s30, v5
    v_dot2_f32_bf16 v9, v159, v159, v9
    v_dot2_f32_bf16 v2, v160, s30, v2
    v_dot2_f32_bf16 v6, v160, v160, v6
    v_dot2_f32_bf16 v3, v161, s30, v3
    v_dot2_f32_bf16 v7, v161, v161, v7
    v_dot2_f32_bf16 v4, v162, s30, v4
    v_dot2_f32_bf16 v8, v162, v162, v8
    v_dot2_f32_bf16 v5, v163, s30, v5
    v_dot2_f32_bf16 v9, v163, v163, v9
    v_dot2_f32_bf16 v2, v164, s30, v2
    v_dot2_f32_bf16 v6, v164, v164, v6
    v_dot2_f32_bf16 v3, v165, s30, v3
    v_dot2_f32_bf16 v7, v165, v165, v7
    v_dot2_f32_bf16 v4, v166, s30, v4
    v_dot2_f32_bf16 v8, v166, v166, v8
    v_dot2_f32_bf16 v5, v167, s30, v5
    v_dot2_f32_bf16 v9, v167, v167, v9
    v_dot2_f32_bf16 v2, v168, s30, v2
    v_dot2_f32_bf16 v6, v168, v168, v6
    v_dot2_f32_bf16 v3, v169, s30, v3
    v_dot2_f32_bf16 v7, v169, v169, v7
    v_dot2_f32_bf16 v4, v170, s30, v4
    v_dot2_f32_bf16 v8, v170, v170, v8
    v_dot2_f32_bf16 v5, v171, s30, v5
    v_dot2_f32_bf16 v9, v171, v171, v9
    v_dot2_f32_bf16 v2, v172, s30, v2
    v_dot2_f32_bf16 v6, v172, v172, v6
    v_dot2_f32_bf16 v3, v173, s30, v3
    v_dot2_f32_bf16 v7, v173, v173, v7
    v_dot2_f32_bf16 v4, v174, s30, v4
    v_dot2_f32_bf16 v8, v174, v174, v8
    v_dot2_f32_bf16 v5, v175, s30, v5
    v_dot2_f32_bf16 v9, v175, v175, v9
    v_dot2_f32_bf16 v2, v176, s30, v2
    v_dot2_f32_bf16 v6, v176, v176, v6
    v_dot2_f32_bf16 v3, v177, s30, v3
    v_dot2_f32_bf16 v7, v177, v177, v7
    v_dot2_f32_bf16 v4, v178, s30, v4
    v_dot2_f32_bf16 v8, v178, v178, v8
    v_dot2_f32_bf16 v5, v179, s30, v5
    v_dot2_f32_bf16 v9, v179, v179, v9
    v_dot2_f32_bf16 v2, v180, s30, v2
    v_dot2_f32_bf16 v6, v180, v180, v6
    v_dot2_f32_bf16 v3, v181, s30, v3
    v_dot2_f32_bf16 v7, v181, v181, v7
    v_dot2_f32_bf16 v4, v182, s30, v4
    v_dot2_f32_bf16 v8, v182, v182, v8
    v_dot2_f32_bf16 v5, v183, s30, v5
    v_dot2_f32_bf16 v9, v183, v183, v9
    v_dot2_f32_bf16 v2, v184, s30, v2
    v_dot2_f32_bf16 v6, v184, v184, v6
    v_dot2_f32_bf16 v3, v185, s30, v3
    v_dot2_f32_bf16 v7, v185, v185, v7
    v_dot2_f32_bf16 v4, v186, s30, v4
    v_dot2_f32_bf16 v8, v186, v186, v8
    v_dot2_f32_bf16 v5, v187, s30, v5
    v_dot2_f32_bf16 v9, v187, v187, v9
    v_dot2_f32_bf16 v2, v188, s30, v2
    v_dot2_f32_bf16 v6, v188, v188, v6
    v_dot2_f32_bf16 v3, v189, s30, v3
    v_dot2_f32_bf16 v7, v189, v189, v7
    v_dot2_f32_bf16 v4, v190, s30, v4
    v_dot2_f32_bf16 v8, v190, v190, v8
    v_dot2_f32_bf16 v5, v191, s30, v5
    v_dot2_f32_bf16 v9, v191, v191, v9
    v_dot2_f32_bf16 v2, v192, s30, v2
    v_dot2_f32_bf16 v6, v192, v192, v6
    v_dot2_f32_bf16 v3, v193, s30, v3
    v_dot2_f32_bf16 v7, v193, v193, v7
    v_dot2_f32_bf16 v4, v194, s30, v4
    v_dot2_f32_bf16 v8, v194, v194, v8
    v_dot2_f32_bf16 v5, v195, s30, v5
    v_dot2_f32_bf16 v9, v195, v195, v9
    v_dot2_f32_bf16 v2, v196, s30, v2
    v_dot2_f32_bf16 v6, v196, v196, v6
    v_dot2_f32_bf16 v3, v197, s30, v3
    v_dot2_f32_bf16 v7, v197, v197, v7
    v_dot2_f32_bf16 v4, v198, s30, v4
    v_dot2_f32_bf16 v8, v198, v198, v8
    v_dot2_f32_bf16 v5, v199, s30, v5
    v_dot2_f32_bf16 v9, v199, v199, v9
    v_dot2_f32_bf16 v2, v200, s30, v2
    v_dot2_f32_bf16 v6, v200, v200, v6
    v_dot2_f32_bf16 v3, v201, s30, v3
    v_dot2_f32_bf16 v7, v201, v201, v7
    v_dot2_f32_bf16 v4, v202, s30, v4
    v_dot2_f32_bf16 v8, v202, v202, v8
    v_dot2_f32_bf16 v5, v203, s30, v5
    v_dot2_f32_bf16 v9, v203, v203, v9
    v_dot2_f32_bf16 v2, v204, s30, v2
    v_dot2_f32_bf16 v6, v204, v204, v6
    v_dot2_f32_bf16 v3, v205, s30, v3
    v_dot2_f32_bf16 v7, v205, v205, v7
    v_dot2_f32_bf16 v4, v206, s30, v4
    v_dot2_f32_bf16 v8, v206, v206, v8
    v_dot2_f32_bf16 v5, v207, s30, v5
    v_dot2_f32_bf16 v9, v207, v207, v9
    v_dot2_f32_bf16 v2, v208, s30, v2
    v_dot2_f32_bf16 v6, v208, v208, v6
    v_dot2_f32_bf16 v3, v209, s30, v3
    v_dot2_f32_bf16 v7, v209, v209, v7
    v_dot2_f32_bf16 v4, v210, s30, v4
    v_dot2_f32_bf16 v8, v210, v210, v8
    v_dot2_f32_bf16 v5, v211, s30, v5
    v_dot2_f32_bf16 v9, v211, v211, v9
    v_dot2_f32_bf16 v2, v212, s30, v2
    v_dot2_f32_bf16 v6, v212, v212, v6
    v_dot2_f32_bf16 v3, v213, s30, v3
    v_dot2_f32_bf16 v7, v213, v213, v7
    v_dot2_f32_bf16 v4, v214, s30, v4
    v_dot2_f32_bf16 v8, v214, v214, v8
    v_dot2_f32_bf16 v5, v215, s30, v5
    v_dot2_f32_bf16 v9, v215, v215, v9
    v_dot2_f32_bf16 v2, v216, s30, v2
    v_dot2_f32_bf16 v6, v216, v216, v6
    v_dot2_f32_bf16 v3, v217, s30, v3
    v_dot2_f32_bf16 v7, v217, v217, v7
    v_dot2_f32_bf16 v4, v218, s30, v4
    v_dot2_f32_bf16 v8, v218, v218, v8
    v_dot2_f32_bf16 v5, v219, s30, v5
    v_dot2_f32_bf16 v9, v219, v219, v9
    v_dot2_f32_bf16 v2, v220, s30, v2
    v_dot2_f32_bf16 v6, v220, v220, v6
    v_dot2_f32_bf16 v3, v221, s30, v3
    v_dot2_f32_bf16 v7, v221, v221, v7
    v_dot2_f32_bf16 v4, v222, s30, v4
    v_dot2_f32_bf16 v8, v222, v222, v8
    v_dot2_f32_bf16 v5, v223, s30, v5
    v_dot2_f32_bf16 v9, v223, v223, v9
    v_dot2_f32_bf16 v2, v224, s30, v2
    v_dot2_f32_bf16 v6, v224, v224, v6
    v_dot2_f32_bf16 v3, v225, s30, v3
    v_dot2_f32_bf16 v7, v225, v225, v7
    v_dot2_f32_bf16 v4, v226, s30, v4
    v_dot2_f32_bf16 v8, v226, v226, v8
    v_dot2_f32_bf16 v5, v227, s30, v5
    v_dot2_f32_bf16 v9, v227, v227, v9
    v_dot2_f32_bf16 v2, v228, s30, v2
    v_dot2_f32_bf16 v6, v228, v228, v6
    v_dot2_f32_bf16 v3, v229, s30, v3
    v_dot2_f32_bf16 v7, v229, v229, v7
    v_dot2_f32_bf16 v4, v230, s30, v4
    v_dot2_f32_bf16 v8, v230, v230, v8
    v_dot2_f32_bf16 v5, v231, s30, v5
    v_dot2_f32_bf16 v9, v231, v231, v9
    v_dot2_f32_bf16 v2, v232, s30, v2
    v_dot2_f32_bf16 v6, v232, v232, v6
    v_dot2_f32_bf16 v3, v233, s30, v3
    v_dot2_f32_bf16 v7, v233, v233, v7
    v_dot2_f32_bf16 v4, v234, s30, v4
    v_dot2_f32_bf16 v8, v234, v234, v8
    v_dot2_f32_bf16 v5, v235, s30, v5
    v_dot2_f32_bf16 v9, v235, v235, v9
    v_dot2_f32_bf16 v2, v236, s30, v2
    v_dot2_f32_bf16 v6, v236, v236, v6
    v_dot2_f32_bf16 v3, v237, s30, v3
    v_dot2_f32_bf16 v7, v237, v237, v7
    v_dot2_f32_bf16 v4, v238, s30, v4
    v_dot2_f32_bf16 v8, v238, v238, v8
    v_dot2_f32_bf16 v5, v239, s30, v5
    v_dot2_f32_bf16 v9, v239, v239, v9
    v_dot2_f32_bf16 v2, v240, s30, v2
    v_dot2_f32_bf16 v6, v240, v240, v6
    v_dot2_f32_bf16 v3, v241, s30, v3
    v_dot2_f32_bf16 v7, v241, v241, v7
    v_dot2_f32_bf16 v4, v242, s30, v4
    v_dot2_f32_bf16 v8, v242, v242, v8
    v_dot2_f32_bf16 v5, v243, s30, v5
    v_dot2_f32_bf16 v9, v243, v243, v9
    v_dot2_f32_bf16 v2, v244, s30, v2
    v_dot2_f32_bf16 v6, v244, v244, v6
    v_dot2_f32_bf16 v3, v245, s30, v3
    v_dot2_f32_bf16 v7, v245, v245, v7
    v_dot2_f32_bf16 v4, v246, s30, v4
    v_dot2_f32_bf16 v8, v246, v246, v8
    v_dot2_f32_bf16 v5, v247, s30, v5
    v_dot2_f32_bf16 v9, v247, v247, v9
    v_dot2_f32_bf16 v2, v248, s30, v2
    v_dot2_f32_bf16 v6, v248, v248, v6
    v_dot2_f32_bf16 v3, v249, s30, v3
    v_dot2_f32_bf16 v7, v249, v249, v7
    v_dot2_f32_bf16 v4, v250, s30, v4
    v_dot2_f32_bf16 v8, v250, v250, v8
    v_dot2_f32_bf16 v5, v251, s30, v5
    v_dot2_f32_bf16 v9, v251, v251, v9
    v_dot2_f32_bf16 v2, v252, s30, v2
    v_dot2_f32_bf16 v6, v252, v252, v6
    v_dot2_f32_bf16 v3, v253, s30, v3
    v_dot2_f32_bf16 v7, v253, v253, v7
    v_dot2_f32_bf16 v4, v254, s30, v4
    v_dot2_f32_bf16 v8, v254, v254, v8
    v_dot2_f32_bf16 v5, v255, s30, v5
    v_dot2_f32_bf16 v9, v255, v255, v9
    v_add_f32 v2, v2, v3
    v_add_f32 v4, v4, v5
    v_add_f32 v6, v6, v7
    v_add_f32 v8, v8, v9
    v_add_f32 v2, v2, v4
    v_add_f32 v6, v6, v8
    v_mov_b32 v3, v2
    v_mov_b32 v7, v6
    s_nop 0
    v_permlane32_swap_b32 v2, v3
    v_permlane32_swap_b32 v6, v7
    v_add_f32 v2, v2, v3
    v_add_f32 v6, v6, v7
    v_mul_f32 v2, 0x3b000000, v2
    v_mul_f32 v6, 0x3b000000, v6
    v_mul_f32 v3, v2, v2
    v_sub_f32 v6, v6, v3
    v_max_f32 v6, 0, v6
    v_add_f32 v6, 0x3727c5ac, v6
    v_rsq_f32 v6, v6
    s_nop 0
    v_mul_f32 v7, v2, v6
    v_sub_f32 v7, 0, v7
    v_lshlrev_b32 v2, 16, v128
    v_and_b32 v3, 0xffff0000, v128
    v_fma_f32 v2, v2, v6, v7
    v_fma_f32 v3, v3, v6, v7
    v_cvt_pk_bf16_f32 v128, v2, v3
    v_lshlrev_b32 v2, 16, v129
    v_and_b32 v3, 0xffff0000, v129
    v_fma_f32 v2, v2, v6, v7
    v_fma_f32 v3, v3, v6, v7
    v_cvt_pk_bf16_f32 v129, v2, v3
    v_lshlrev_b32 v2, 16, v130
    v_and_b32 v3, 0xffff0000, v130
    v_fma_f32 v2, v2, v6, v7
    v_fma_f32 v3, v3, v6, v7
    v_cvt_pk_bf16_f32 v130, v2, v3
    v_lshlrev_b32 v2, 16, v131
    v_and_b32 v3, 0xffff0000, v131
    v_fma_f32 v2, v2, v6, v7
    v_fma_f32 v3, v3, v6, v7
    v_cvt_pk_bf16_f32 v131, v2, v3
    v_lshlrev_b32 v2, 16, v132
    v_and_b32 v3, 0xffff0000, v132
    v_fma_f32 v2, v2, v6, v7
    v_fma_f32 v3, v3, v6, v7
    v_cvt_pk_bf16_f32 v132, v2, v3
    v_lshlrev_b32 v2, 16, v133
    v_and_b32 v3, 0xffff0000, v133
    v_fma_f32 v2, v2, v6, v7
    v_fma_f32 v3, v3, v6, v7
    v_cvt_pk_bf16_f32 v133, v2, v3
    v_lshlrev_b32 v2, 16, v134
    v_and_b32 v3, 0xffff0000, v134
    v_fma_f32 v2, v2, v6, v7
    v_fma_f32 v3, v3, v6, v7
    v_cvt_pk_bf16_f32 v134, v2, v3
    v_lshlrev_b32 v2, 16, v135
    v_and_b32 v3, 0xffff0000, v135
    v_fma_f32 v2, v2, v6, v7
    v_fma_f32 v3, v3, v6, v7
    v_cvt_pk_bf16_f32 v135, v2, v3
    v_lshlrev_b32 v2, 16, v136
    v_and_b32 v3, 0xffff0000, v136
    v_fma_f32 v2, v2, v6, v7
    v_fma_f32 v3, v3, v6, v7
    v_cvt_pk_bf16_f32 v136, v2, v3
    v_lshlrev_b32 v2, 16, v137
    v_and_b32 v3, 0xffff0000, v137
    v_fma_f32 v2, v2, v6, v7
    v_fma_f32 v3, v3, v6, v7
    v_cvt_pk_bf16_f32 v137, v2, v3
    v_lshlrev_b32 v2, 16, v138
    v_and_b32 v3, 0xffff0000, v138
    v_fma_f32 v2, v2, v6, v7
    v_fma_f32 v3, v3, v6, v7
    v_cvt_pk_bf16_f32 v138, v2, v3
    v_lshlrev_b32 v2, 16, v139
    v_and_b32 v3, 0xffff0000, v139
    v_fma_f32 v2, v2, v6, v7
    v_fma_f32 v3, v3, v6, v7
    v_cvt_pk_bf16_f32 v139, v2, v3
    v_lshlrev_b32 v2, 16, v140
    v_and_b32 v3, 0xffff0000, v140
    v_fma_f32 v2, v2, v6, v7
    v_fma_f32 v3, v3, v6, v7
    v_cvt_pk_bf16_f32 v140, v2, v3
    v_lshlrev_b32 v2, 16, v141
    v_and_b32 v3, 0xffff0000, v141
    v_fma_f32 v2, v2, v6, v7
    v_fma_f32 v3, v3, v6, v7
    v_cvt_pk_bf16_f32 v141, v2, v3
    v_lshlrev_b32 v2, 16, v142
    v_and_b32 v3, 0xffff0000, v142
    v_fma_f32 v2, v2, v6, v7
    v_fma_f32 v3, v3, v6, v7
    v_cvt_pk_bf16_f32 v142, v2, v3
    v_lshlrev_b32 v2, 16, v143
    v_and_b32 v3, 0xffff0000, v143
    v_fma_f32 v2, v2, v6, v7
    v_fma_f32 v3, v3, v6, v7
    v_cvt_pk_bf16_f32 v143, v2, v3
    v_lshlrev_b32 v2, 16, v144
    v_and_b32 v3, 0xffff0000, v144
    v_fma_f32 v2, v2, v6, v7
    v_fma_f32 v3, v3, v6, v7
    v_cvt_pk_bf16_f32 v144, v2, v3
    v_lshlrev_b32 v2, 16, v145
    v_and_b32 v3, 0xffff0000, v145
    v_fma_f32 v2, v2, v6, v7
    v_fma_f32 v3, v3, v6, v7
    v_cvt_pk_bf16_f32 v145, v2, v3
    v_lshlrev_b32 v2, 16, v146
    v_and_b32 v3, 0xffff0000, v146
    v_fma_f32 v2, v2, v6, v7
    v_fma_f32 v3, v3, v6, v7
    v_cvt_pk_bf16_f32 v146, v2, v3
    v_lshlrev_b32 v2, 16, v147
    v_and_b32 v3, 0xffff0000, v147
    v_fma_f32 v2, v2, v6, v7
    v_fma_f32 v3, v3, v6, v7
    v_cvt_pk_bf16_f32 v147, v2, v3
    v_lshlrev_b32 v2, 16, v148
    v_and_b32 v3, 0xffff0000, v148
    v_fma_f32 v2, v2, v6, v7
    v_fma_f32 v3, v3, v6, v7
    v_cvt_pk_bf16_f32 v148, v2, v3
    v_lshlrev_b32 v2, 16, v149
    v_and_b32 v3, 0xffff0000, v149
    v_fma_f32 v2, v2, v6, v7
    v_fma_f32 v3, v3, v6, v7
    v_cvt_pk_bf16_f32 v149, v2, v3
    v_lshlrev_b32 v2, 16, v150
    v_and_b32 v3, 0xffff0000, v150
    v_fma_f32 v2, v2, v6, v7
    v_fma_f32 v3, v3, v6, v7
    v_cvt_pk_bf16_f32 v150, v2, v3
    v_lshlrev_b32 v2, 16, v151
    v_and_b32 v3, 0xffff0000, v151
    v_fma_f32 v2, v2, v6, v7
    v_fma_f32 v3, v3, v6, v7
    v_cvt_pk_bf16_f32 v151, v2, v3
    v_lshlrev_b32 v2, 16, v152
    v_and_b32 v3, 0xffff0000, v152
    v_fma_f32 v2, v2, v6, v7
    v_fma_f32 v3, v3, v6, v7
    v_cvt_pk_bf16_f32 v152, v2, v3
    v_lshlrev_b32 v2, 16, v153
    v_and_b32 v3, 0xffff0000, v153
    v_fma_f32 v2, v2, v6, v7
    v_fma_f32 v3, v3, v6, v7
    v_cvt_pk_bf16_f32 v153, v2, v3
    v_lshlrev_b32 v2, 16, v154
    v_and_b32 v3, 0xffff0000, v154
    v_fma_f32 v2, v2, v6, v7
    v_fma_f32 v3, v3, v6, v7
    v_cvt_pk_bf16_f32 v154, v2, v3
    v_lshlrev_b32 v2, 16, v155
    v_and_b32 v3, 0xffff0000, v155
    v_fma_f32 v2, v2, v6, v7
    v_fma_f32 v3, v3, v6, v7
    v_cvt_pk_bf16_f32 v155, v2, v3
    v_lshlrev_b32 v2, 16, v156
    v_and_b32 v3, 0xffff0000, v156
    v_fma_f32 v2, v2, v6, v7
    v_fma_f32 v3, v3, v6, v7
    v_cvt_pk_bf16_f32 v156, v2, v3
    v_lshlrev_b32 v2, 16, v157
    v_and_b32 v3, 0xffff0000, v157
    v_fma_f32 v2, v2, v6, v7
    v_fma_f32 v3, v3, v6, v7
    v_cvt_pk_bf16_f32 v157, v2, v3
    v_lshlrev_b32 v2, 16, v158
    v_and_b32 v3, 0xffff0000, v158
    v_fma_f32 v2, v2, v6, v7
    v_fma_f32 v3, v3, v6, v7
    v_cvt_pk_bf16_f32 v158, v2, v3
    v_lshlrev_b32 v2, 16, v159
    v_and_b32 v3, 0xffff0000, v159
    v_fma_f32 v2, v2, v6, v7
    v_fma_f32 v3, v3, v6, v7
    v_cvt_pk_bf16_f32 v159, v2, v3
    v_lshlrev_b32 v2, 16, v160
    v_and_b32 v3, 0xffff0000, v160
    v_fma_f32 v2, v2, v6, v7
    v_fma_f32 v3, v3, v6, v7
    v_cvt_pk_bf16_f32 v160, v2, v3
    v_lshlrev_b32 v2, 16, v161
    v_and_b32 v3, 0xffff0000, v161
    v_fma_f32 v2, v2, v6, v7
    v_fma_f32 v3, v3, v6, v7
    v_cvt_pk_bf16_f32 v161, v2, v3
    v_lshlrev_b32 v2, 16, v162
    v_and_b32 v3, 0xffff0000, v162
    v_fma_f32 v2, v2, v6, v7
    v_fma_f32 v3, v3, v6, v7
    v_cvt_pk_bf16_f32 v162, v2, v3
    v_lshlrev_b32 v2, 16, v163
    v_and_b32 v3, 0xffff0000, v163
    v_fma_f32 v2, v2, v6, v7
    v_fma_f32 v3, v3, v6, v7
    v_cvt_pk_bf16_f32 v163, v2, v3
    v_lshlrev_b32 v2, 16, v164
    v_and_b32 v3, 0xffff0000, v164
    v_fma_f32 v2, v2, v6, v7
    v_fma_f32 v3, v3, v6, v7
    v_cvt_pk_bf16_f32 v164, v2, v3
    v_lshlrev_b32 v2, 16, v165
    v_and_b32 v3, 0xffff0000, v165
    v_fma_f32 v2, v2, v6, v7
    v_fma_f32 v3, v3, v6, v7
    v_cvt_pk_bf16_f32 v165, v2, v3
    v_lshlrev_b32 v2, 16, v166
    v_and_b32 v3, 0xffff0000, v166
    v_fma_f32 v2, v2, v6, v7
    v_fma_f32 v3, v3, v6, v7
    v_cvt_pk_bf16_f32 v166, v2, v3
    v_lshlrev_b32 v2, 16, v167
    v_and_b32 v3, 0xffff0000, v167
    v_fma_f32 v2, v2, v6, v7
    v_fma_f32 v3, v3, v6, v7
    v_cvt_pk_bf16_f32 v167, v2, v3
    v_lshlrev_b32 v2, 16, v168
    v_and_b32 v3, 0xffff0000, v168
    v_fma_f32 v2, v2, v6, v7
    v_fma_f32 v3, v3, v6, v7
    v_cvt_pk_bf16_f32 v168, v2, v3
    v_lshlrev_b32 v2, 16, v169
    v_and_b32 v3, 0xffff0000, v169
    v_fma_f32 v2, v2, v6, v7
    v_fma_f32 v3, v3, v6, v7
    v_cvt_pk_bf16_f32 v169, v2, v3
    v_lshlrev_b32 v2, 16, v170
    v_and_b32 v3, 0xffff0000, v170
    v_fma_f32 v2, v2, v6, v7
    v_fma_f32 v3, v3, v6, v7
    v_cvt_pk_bf16_f32 v170, v2, v3
    v_lshlrev_b32 v2, 16, v171
    v_and_b32 v3, 0xffff0000, v171
    v_fma_f32 v2, v2, v6, v7
    v_fma_f32 v3, v3, v6, v7
    v_cvt_pk_bf16_f32 v171, v2, v3
    v_lshlrev_b32 v2, 16, v172
    v_and_b32 v3, 0xffff0000, v172
    v_fma_f32 v2, v2, v6, v7
    v_fma_f32 v3, v3, v6, v7
    v_cvt_pk_bf16_f32 v172, v2, v3
    v_lshlrev_b32 v2, 16, v173
    v_and_b32 v3, 0xffff0000, v173
    v_fma_f32 v2, v2, v6, v7
    v_fma_f32 v3, v3, v6, v7
    v_cvt_pk_bf16_f32 v173, v2, v3
    v_lshlrev_b32 v2, 16, v174
    v_and_b32 v3, 0xffff0000, v174
    v_fma_f32 v2, v2, v6, v7
    v_fma_f32 v3, v3, v6, v7
    v_cvt_pk_bf16_f32 v174, v2, v3
    v_lshlrev_b32 v2, 16, v175
    v_and_b32 v3, 0xffff0000, v175
    v_fma_f32 v2, v2, v6, v7
    v_fma_f32 v3, v3, v6, v7
    v_cvt_pk_bf16_f32 v175, v2, v3
    v_lshlrev_b32 v2, 16, v176
    v_and_b32 v3, 0xffff0000, v176
    v_fma_f32 v2, v2, v6, v7
    v_fma_f32 v3, v3, v6, v7
    v_cvt_pk_bf16_f32 v176, v2, v3
    v_lshlrev_b32 v2, 16, v177
    v_and_b32 v3, 0xffff0000, v177
    v_fma_f32 v2, v2, v6, v7
    v_fma_f32 v3, v3, v6, v7
    v_cvt_pk_bf16_f32 v177, v2, v3
    v_lshlrev_b32 v2, 16, v178
    v_and_b32 v3, 0xffff0000, v178
    v_fma_f32 v2, v2, v6, v7
    v_fma_f32 v3, v3, v6, v7
    v_cvt_pk_bf16_f32 v178, v2, v3
    v_lshlrev_b32 v2, 16, v179
    v_and_b32 v3, 0xffff0000, v179
    v_fma_f32 v2, v2, v6, v7
    v_fma_f32 v3, v3, v6, v7
    v_cvt_pk_bf16_f32 v179, v2, v3
    v_lshlrev_b32 v2, 16, v180
    v_and_b32 v3, 0xffff0000, v180
    v_fma_f32 v2, v2, v6, v7
    v_fma_f32 v3, v3, v6, v7
    v_cvt_pk_bf16_f32 v180, v2, v3
    v_lshlrev_b32 v2, 16, v181
    v_and_b32 v3, 0xffff0000, v181
    v_fma_f32 v2, v2, v6, v7
    v_fma_f32 v3, v3, v6, v7
    v_cvt_pk_bf16_f32 v181, v2, v3
    v_lshlrev_b32 v2, 16, v182
    v_and_b32 v3, 0xffff0000, v182
    v_fma_f32 v2, v2, v6, v7
    v_fma_f32 v3, v3, v6, v7
    v_cvt_pk_bf16_f32 v182, v2, v3
    v_lshlrev_b32 v2, 16, v183
    v_and_b32 v3, 0xffff0000, v183
    v_fma_f32 v2, v2, v6, v7
    v_fma_f32 v3, v3, v6, v7
    v_cvt_pk_bf16_f32 v183, v2, v3
    v_lshlrev_b32 v2, 16, v184
    v_and_b32 v3, 0xffff0000, v184
    v_fma_f32 v2, v2, v6, v7
    v_fma_f32 v3, v3, v6, v7
    v_cvt_pk_bf16_f32 v184, v2, v3
    v_lshlrev_b32 v2, 16, v185
    v_and_b32 v3, 0xffff0000, v185
    v_fma_f32 v2, v2, v6, v7
    v_fma_f32 v3, v3, v6, v7
    v_cvt_pk_bf16_f32 v185, v2, v3
    v_lshlrev_b32 v2, 16, v186
    v_and_b32 v3, 0xffff0000, v186
    v_fma_f32 v2, v2, v6, v7
    v_fma_f32 v3, v3, v6, v7
    v_cvt_pk_bf16_f32 v186, v2, v3
    v_lshlrev_b32 v2, 16, v187
    v_and_b32 v3, 0xffff0000, v187
    v_fma_f32 v2, v2, v6, v7
    v_fma_f32 v3, v3, v6, v7
    v_cvt_pk_bf16_f32 v187, v2, v3
    v_lshlrev_b32 v2, 16, v188
    v_and_b32 v3, 0xffff0000, v188
    v_fma_f32 v2, v2, v6, v7
    v_fma_f32 v3, v3, v6, v7
    v_cvt_pk_bf16_f32 v188, v2, v3
    v_lshlrev_b32 v2, 16, v189
    v_and_b32 v3, 0xffff0000, v189
    v_fma_f32 v2, v2, v6, v7
    v_fma_f32 v3, v3, v6, v7
    v_cvt_pk_bf16_f32 v189, v2, v3
    v_lshlrev_b32 v2, 16, v190
    v_and_b32 v3, 0xffff0000, v190
    v_fma_f32 v2, v2, v6, v7
    v_fma_f32 v3, v3, v6, v7
    v_cvt_pk_bf16_f32 v190, v2, v3
    v_lshlrev_b32 v2, 16, v191
    v_and_b32 v3, 0xffff0000, v191
    v_fma_f32 v2, v2, v6, v7
    v_fma_f32 v3, v3, v6, v7
    v_cvt_pk_bf16_f32 v191, v2, v3
    v_lshlrev_b32 v2, 16, v192
    v_and_b32 v3, 0xffff0000, v192
    v_fma_f32 v2, v2, v6, v7
    v_fma_f32 v3, v3, v6, v7
    v_cvt_pk_bf16_f32 v192, v2, v3
    v_lshlrev_b32 v2, 16, v193
    v_and_b32 v3, 0xffff0000, v193
    v_fma_f32 v2, v2, v6, v7
    v_fma_f32 v3, v3, v6, v7
    v_cvt_pk_bf16_f32 v193, v2, v3
    v_lshlrev_b32 v2, 16, v194
    v_and_b32 v3, 0xffff0000, v194
    v_fma_f32 v2, v2, v6, v7
    v_fma_f32 v3, v3, v6, v7
    v_cvt_pk_bf16_f32 v194, v2, v3
    v_lshlrev_b32 v2, 16, v195
    v_and_b32 v3, 0xffff0000, v195
    v_fma_f32 v2, v2, v6, v7
    v_fma_f32 v3, v3, v6, v7
    v_cvt_pk_bf16_f32 v195, v2, v3
    v_lshlrev_b32 v2, 16, v196
    v_and_b32 v3, 0xffff0000, v196
    v_fma_f32 v2, v2, v6, v7
    v_fma_f32 v3, v3, v6, v7
    v_cvt_pk_bf16_f32 v196, v2, v3
    v_lshlrev_b32 v2, 16, v197
    v_and_b32 v3, 0xffff0000, v197
    v_fma_f32 v2, v2, v6, v7
    v_fma_f32 v3, v3, v6, v7
    v_cvt_pk_bf16_f32 v197, v2, v3
    v_lshlrev_b32 v2, 16, v198
    v_and_b32 v3, 0xffff0000, v198
    v_fma_f32 v2, v2, v6, v7
    v_fma_f32 v3, v3, v6, v7
    v_cvt_pk_bf16_f32 v198, v2, v3
    v_lshlrev_b32 v2, 16, v199
    v_and_b32 v3, 0xffff0000, v199
    v_fma_f32 v2, v2, v6, v7
    v_fma_f32 v3, v3, v6, v7
    v_cvt_pk_bf16_f32 v199, v2, v3
    v_lshlrev_b32 v2, 16, v200
    v_and_b32 v3, 0xffff0000, v200
    v_fma_f32 v2, v2, v6, v7
    v_fma_f32 v3, v3, v6, v7
    v_cvt_pk_bf16_f32 v200, v2, v3
    v_lshlrev_b32 v2, 16, v201
    v_and_b32 v3, 0xffff0000, v201
    v_fma_f32 v2, v2, v6, v7
    v_fma_f32 v3, v3, v6, v7
    v_cvt_pk_bf16_f32 v201, v2, v3
    v_lshlrev_b32 v2, 16, v202
    v_and_b32 v3, 0xffff0000, v202
    v_fma_f32 v2, v2, v6, v7
    v_fma_f32 v3, v3, v6, v7
    v_cvt_pk_bf16_f32 v202, v2, v3
    v_lshlrev_b32 v2, 16, v203
    v_and_b32 v3, 0xffff0000, v203
    v_fma_f32 v2, v2, v6, v7
    v_fma_f32 v3, v3, v6, v7
    v_cvt_pk_bf16_f32 v203, v2, v3
    v_lshlrev_b32 v2, 16, v204
    v_and_b32 v3, 0xffff0000, v204
    v_fma_f32 v2, v2, v6, v7
    v_fma_f32 v3, v3, v6, v7
    v_cvt_pk_bf16_f32 v204, v2, v3
    v_lshlrev_b32 v2, 16, v205
    v_and_b32 v3, 0xffff0000, v205
    v_fma_f32 v2, v2, v6, v7
    v_fma_f32 v3, v3, v6, v7
    v_cvt_pk_bf16_f32 v205, v2, v3
    v_lshlrev_b32 v2, 16, v206
    v_and_b32 v3, 0xffff0000, v206
    v_fma_f32 v2, v2, v6, v7
    v_fma_f32 v3, v3, v6, v7
    v_cvt_pk_bf16_f32 v206, v2, v3
    v_lshlrev_b32 v2, 16, v207
    v_and_b32 v3, 0xffff0000, v207
    v_fma_f32 v2, v2, v6, v7
    v_fma_f32 v3, v3, v6, v7
    v_cvt_pk_bf16_f32 v207, v2, v3
    v_lshlrev_b32 v2, 16, v208
    v_and_b32 v3, 0xffff0000, v208
    v_fma_f32 v2, v2, v6, v7
    v_fma_f32 v3, v3, v6, v7
    v_cvt_pk_bf16_f32 v208, v2, v3
    v_lshlrev_b32 v2, 16, v209
    v_and_b32 v3, 0xffff0000, v209
    v_fma_f32 v2, v2, v6, v7
    v_fma_f32 v3, v3, v6, v7
    v_cvt_pk_bf16_f32 v209, v2, v3
    v_lshlrev_b32 v2, 16, v210
    v_and_b32 v3, 0xffff0000, v210
    v_fma_f32 v2, v2, v6, v7
    v_fma_f32 v3, v3, v6, v7
    v_cvt_pk_bf16_f32 v210, v2, v3
    v_lshlrev_b32 v2, 16, v211
    v_and_b32 v3, 0xffff0000, v211
    v_fma_f32 v2, v2, v6, v7
    v_fma_f32 v3, v3, v6, v7
    v_cvt_pk_bf16_f32 v211, v2, v3
    v_lshlrev_b32 v2, 16, v212
    v_and_b32 v3, 0xffff0000, v212
    v_fma_f32 v2, v2, v6, v7
    v_fma_f32 v3, v3, v6, v7
    v_cvt_pk_bf16_f32 v212, v2, v3
    v_lshlrev_b32 v2, 16, v213
    v_and_b32 v3, 0xffff0000, v213
    v_fma_f32 v2, v2, v6, v7
    v_fma_f32 v3, v3, v6, v7
    v_cvt_pk_bf16_f32 v213, v2, v3
    v_lshlrev_b32 v2, 16, v214
    v_and_b32 v3, 0xffff0000, v214
    v_fma_f32 v2, v2, v6, v7
    v_fma_f32 v3, v3, v6, v7
    v_cvt_pk_bf16_f32 v214, v2, v3
    v_lshlrev_b32 v2, 16, v215
    v_and_b32 v3, 0xffff0000, v215
    v_fma_f32 v2, v2, v6, v7
    v_fma_f32 v3, v3, v6, v7
    v_cvt_pk_bf16_f32 v215, v2, v3
    v_lshlrev_b32 v2, 16, v216
    v_and_b32 v3, 0xffff0000, v216
    v_fma_f32 v2, v2, v6, v7
    v_fma_f32 v3, v3, v6, v7
    v_cvt_pk_bf16_f32 v216, v2, v3
    v_lshlrev_b32 v2, 16, v217
    v_and_b32 v3, 0xffff0000, v217
    v_fma_f32 v2, v2, v6, v7
    v_fma_f32 v3, v3, v6, v7
    v_cvt_pk_bf16_f32 v217, v2, v3
    v_lshlrev_b32 v2, 16, v218
    v_and_b32 v3, 0xffff0000, v218
    v_fma_f32 v2, v2, v6, v7
    v_fma_f32 v3, v3, v6, v7
    v_cvt_pk_bf16_f32 v218, v2, v3
    v_lshlrev_b32 v2, 16, v219
    v_and_b32 v3, 0xffff0000, v219
    v_fma_f32 v2, v2, v6, v7
    v_fma_f32 v3, v3, v6, v7
    v_cvt_pk_bf16_f32 v219, v2, v3
    v_lshlrev_b32 v2, 16, v220
    v_and_b32 v3, 0xffff0000, v220
    v_fma_f32 v2, v2, v6, v7
    v_fma_f32 v3, v3, v6, v7
    v_cvt_pk_bf16_f32 v220, v2, v3
    v_lshlrev_b32 v2, 16, v221
    v_and_b32 v3, 0xffff0000, v221
    v_fma_f32 v2, v2, v6, v7
    v_fma_f32 v3, v3, v6, v7
    v_cvt_pk_bf16_f32 v221, v2, v3
    v_lshlrev_b32 v2, 16, v222
    v_and_b32 v3, 0xffff0000, v222
    v_fma_f32 v2, v2, v6, v7
    v_fma_f32 v3, v3, v6, v7
    v_cvt_pk_bf16_f32 v222, v2, v3
    v_lshlrev_b32 v2, 16, v223
    v_and_b32 v3, 0xffff0000, v223
    v_fma_f32 v2, v2, v6, v7
    v_fma_f32 v3, v3, v6, v7
    v_cvt_pk_bf16_f32 v223, v2, v3
    v_lshlrev_b32 v2, 16, v224
    v_and_b32 v3, 0xffff0000, v224
    v_fma_f32 v2, v2, v6, v7
    v_fma_f32 v3, v3, v6, v7
    v_cvt_pk_bf16_f32 v224, v2, v3
    v_lshlrev_b32 v2, 16, v225
    v_and_b32 v3, 0xffff0000, v225
    v_fma_f32 v2, v2, v6, v7
    v_fma_f32 v3, v3, v6, v7
    v_cvt_pk_bf16_f32 v225, v2, v3
    v_lshlrev_b32 v2, 16, v226
    v_and_b32 v3, 0xffff0000, v226
    v_fma_f32 v2, v2, v6, v7
    v_fma_f32 v3, v3, v6, v7
    v_cvt_pk_bf16_f32 v226, v2, v3
    v_lshlrev_b32 v2, 16, v227
    v_and_b32 v3, 0xffff0000, v227
    v_fma_f32 v2, v2, v6, v7
    v_fma_f32 v3, v3, v6, v7
    v_cvt_pk_bf16_f32 v227, v2, v3
    v_lshlrev_b32 v2, 16, v228
    v_and_b32 v3, 0xffff0000, v228
    v_fma_f32 v2, v2, v6, v7
    v_fma_f32 v3, v3, v6, v7
    v_cvt_pk_bf16_f32 v228, v2, v3
    v_lshlrev_b32 v2, 16, v229
    v_and_b32 v3, 0xffff0000, v229
    v_fma_f32 v2, v2, v6, v7
    v_fma_f32 v3, v3, v6, v7
    v_cvt_pk_bf16_f32 v229, v2, v3
    v_lshlrev_b32 v2, 16, v230
    v_and_b32 v3, 0xffff0000, v230
    v_fma_f32 v2, v2, v6, v7
    v_fma_f32 v3, v3, v6, v7
    v_cvt_pk_bf16_f32 v230, v2, v3
    v_lshlrev_b32 v2, 16, v231
    v_and_b32 v3, 0xffff0000, v231
    v_fma_f32 v2, v2, v6, v7
    v_fma_f32 v3, v3, v6, v7
    v_cvt_pk_bf16_f32 v231, v2, v3
    v_lshlrev_b32 v2, 16, v232
    v_and_b32 v3, 0xffff0000, v232
    v_fma_f32 v2, v2, v6, v7
    v_fma_f32 v3, v3, v6, v7
    v_cvt_pk_bf16_f32 v232, v2, v3
    v_lshlrev_b32 v2, 16, v233
    v_and_b32 v3, 0xffff0000, v233
    v_fma_f32 v2, v2, v6, v7
    v_fma_f32 v3, v3, v6, v7
    v_cvt_pk_bf16_f32 v233, v2, v3
    v_lshlrev_b32 v2, 16, v234
    v_and_b32 v3, 0xffff0000, v234
    v_fma_f32 v2, v2, v6, v7
    v_fma_f32 v3, v3, v6, v7
    v_cvt_pk_bf16_f32 v234, v2, v3
    v_lshlrev_b32 v2, 16, v235
    v_and_b32 v3, 0xffff0000, v235
    v_fma_f32 v2, v2, v6, v7
    v_fma_f32 v3, v3, v6, v7
    v_cvt_pk_bf16_f32 v235, v2, v3
    v_lshlrev_b32 v2, 16, v236
    v_and_b32 v3, 0xffff0000, v236
    v_fma_f32 v2, v2, v6, v7
    v_fma_f32 v3, v3, v6, v7
    v_cvt_pk_bf16_f32 v236, v2, v3
    v_lshlrev_b32 v2, 16, v237
    v_and_b32 v3, 0xffff0000, v237
    v_fma_f32 v2, v2, v6, v7
    v_fma_f32 v3, v3, v6, v7
    v_cvt_pk_bf16_f32 v237, v2, v3
    v_lshlrev_b32 v2, 16, v238
    v_and_b32 v3, 0xffff0000, v238
    v_fma_f32 v2, v2, v6, v7
    v_fma_f32 v3, v3, v6, v7
    v_cvt_pk_bf16_f32 v238, v2, v3
    v_lshlrev_b32 v2, 16, v239
    v_and_b32 v3, 0xffff0000, v239
    v_fma_f32 v2, v2, v6, v7
    v_fma_f32 v3, v3, v6, v7
    v_cvt_pk_bf16_f32 v239, v2, v3
    v_lshlrev_b32 v2, 16, v240
    v_and_b32 v3, 0xffff0000, v240
    v_fma_f32 v2, v2, v6, v7
    v_fma_f32 v3, v3, v6, v7
    v_cvt_pk_bf16_f32 v240, v2, v3
    v_lshlrev_b32 v2, 16, v241
    v_and_b32 v3, 0xffff0000, v241
    v_fma_f32 v2, v2, v6, v7
    v_fma_f32 v3, v3, v6, v7
    v_cvt_pk_bf16_f32 v241, v2, v3
    v_lshlrev_b32 v2, 16, v242
    v_and_b32 v3, 0xffff0000, v242
    v_fma_f32 v2, v2, v6, v7
    v_fma_f32 v3, v3, v6, v7
    v_cvt_pk_bf16_f32 v242, v2, v3
    v_lshlrev_b32 v2, 16, v243
    v_and_b32 v3, 0xffff0000, v243
    v_fma_f32 v2, v2, v6, v7
    v_fma_f32 v3, v3, v6, v7
    v_cvt_pk_bf16_f32 v243, v2, v3
    v_lshlrev_b32 v2, 16, v244
    v_and_b32 v3, 0xffff0000, v244
    v_fma_f32 v2, v2, v6, v7
    v_fma_f32 v3, v3, v6, v7
    v_cvt_pk_bf16_f32 v244, v2, v3
    v_lshlrev_b32 v2, 16, v245
    v_and_b32 v3, 0xffff0000, v245
    v_fma_f32 v2, v2, v6, v7
    v_fma_f32 v3, v3, v6, v7
    v_cvt_pk_bf16_f32 v245, v2, v3
    v_lshlrev_b32 v2, 16, v246
    v_and_b32 v3, 0xffff0000, v246
    v_fma_f32 v2, v2, v6, v7
    v_fma_f32 v3, v3, v6, v7
    v_cvt_pk_bf16_f32 v246, v2, v3
    v_lshlrev_b32 v2, 16, v247
    v_and_b32 v3, 0xffff0000, v247
    v_fma_f32 v2, v2, v6, v7
    v_fma_f32 v3, v3, v6, v7
    v_cvt_pk_bf16_f32 v247, v2, v3
    v_lshlrev_b32 v2, 16, v248
    v_and_b32 v3, 0xffff0000, v248
    v_fma_f32 v2, v2, v6, v7
    v_fma_f32 v3, v3, v6, v7
    v_cvt_pk_bf16_f32 v248, v2, v3
    v_lshlrev_b32 v2, 16, v249
    v_and_b32 v3, 0xffff0000, v249
    v_fma_f32 v2, v2, v6, v7
    v_fma_f32 v3, v3, v6, v7
    v_cvt_pk_bf16_f32 v249, v2, v3
    v_lshlrev_b32 v2, 16, v250
    v_and_b32 v3, 0xffff0000, v250
    v_fma_f32 v2, v2, v6, v7
    v_fma_f32 v3, v3, v6, v7
    v_cvt_pk_bf16_f32 v250, v2, v3
    v_lshlrev_b32 v2, 16, v251
    v_and_b32 v3, 0xffff0000, v251
    v_fma_f32 v2, v2, v6, v7
    v_fma_f32 v3, v3, v6, v7
    v_cvt_pk_bf16_f32 v251, v2, v3
    v_lshlrev_b32 v2, 16, v252
    v_and_b32 v3, 0xffff0000, v252
    v_fma_f32 v2, v2, v6, v7
    v_fma_f32 v3, v3, v6, v7
    v_cvt_pk_bf16_f32 v252, v2, v3
    v_lshlrev_b32 v2, 16, v253
    v_and_b32 v3, 0xffff0000, v253
    v_fma_f32 v2, v2, v6, v7
    v_fma_f32 v3, v3, v6, v7
    v_cvt_pk_bf16_f32 v253, v2, v3
    v_lshlrev_b32 v2, 16, v254
    v_and_b32 v3, 0xffff0000, v254
    v_fma_f32 v2, v2, v6, v7
    v_fma_f32 v3, v3, v6, v7
    v_cvt_pk_bf16_f32 v254, v2, v3
    v_lshlrev_b32 v2, 16, v255
    v_and_b32 v3, 0xffff0000, v255
    v_fma_f32 v2, v2, v6, v7
    v_fma_f32 v3, v3, v6, v7
    v_cvt_pk_bf16_f32 v255, v2, v3
    v_and_b32 v1, 63, v0
    v_lshrrev_b32 v2, 5, v1
    v_bfe_u32 v3, v1, 2, 2
    v_lshl_add_u32 v2, v2, 3, v3
    v_lshlrev_b32 v2, 6, v2
    v_bfe_u32 v3, v1, 4, 1
    v_lshl_add_u32 v2, v3, 5, v2
    v_and_b32 v3, 3, v1
    v_lshl_add_u32 v12, v3, 3, v2
    s_waitcnt lgkmcnt(0)
    s_barrier
    ds_read_b64_tr_b16 v[32:33], v12 offset:0
    ds_read_b64_tr_b16 v[34:35], v12 offset:256
    ds_read_b64_tr_b16 v[36:37], v12 offset:1024
    ds_read_b64_tr_b16 v[38:39], v12 offset:1280
    ds_read_b64_tr_b16 v[40:41], v12 offset:2048
    ds_read_b64_tr_b16 v[42:43], v12 offset:2304
    ds_read_b64_tr_b16 v[44:45], v12 offset:3072
    ds_read_b64_tr_b16 v[46:47], v12 offset:3328
    s_waitcnt lgkmcnt(6)
    v_mfma_f32_32x32x16_bf16 v[16:31], v[32:35], v[128:131], 0
    ds_read_b64_tr_b16 v[32:33], v12 offset:4096
    ds_read_b64_tr_b16 v[34:35], v12 offset:4352
    s_waitcnt lgkmcnt(6)
    v_mfma_f32_32x32x16_bf16 v[16:31], v[36:39], v[132:135], v[16:31]
    ds_read_b64_tr_b16 v[36:37], v12 offset:5120
    ds_read_b64_tr_b16 v[38:39], v12 offset:5376
    s_waitcnt lgkmcnt(6)
    v_mfma_f32_32x32x16_bf16 v[16:31], v[40:43], v[136:139], v[16:31]
    ds_read_b64_tr_b16 v[40:41], v12 offset:6144
    ds_read_b64_tr_b16 v[42:43], v12 offset:6400
    s_waitcnt lgkmcnt(6)
    v_mfma_f32_32x32x16_bf16 v[16:31], v[44:47], v[140:143], v[16:31]
    ds_read_b64_tr_b16 v[44:45], v12 offset:7168
    ds_read_b64_tr_b16 v[46:47], v12 offset:7424
    s_waitcnt lgkmcnt(6)
    v_mfma_f32_32x32x16_bf16 v[16:31], v[32:35], v[144:147], v[16:31]
    ds_read_b64_tr_b16 v[32:33], v12 offset:8192
    ds_read_b64_tr_b16 v[34:35], v12 offset:8448
    s_waitcnt lgkmcnt(6)
    v_mfma_f32_32x32x16_bf16 v[16:31], v[36:39], v[148:151], v[16:31]
    ds_read_b64_tr_b16 v[36:37], v12 offset:9216
    ds_read_b64_tr_b16 v[38:39], v12 offset:9472
    s_waitcnt lgkmcnt(6)
    v_mfma_f32_32x32x16_bf16 v[16:31], v[40:43], v[152:155], v[16:31]
    ds_read_b64_tr_b16 v[40:41], v12 offset:10240
    ds_read_b64_tr_b16 v[42:43], v12 offset:10496
    s_waitcnt lgkmcnt(6)
    v_mfma_f32_32x32x16_bf16 v[16:31], v[44:47], v[156:159], v[16:31]
    ds_read_b64_tr_b16 v[44:45], v12 offset:11264
    ds_read_b64_tr_b16 v[46:47], v12 offset:11520
    s_waitcnt lgkmcnt(6)
    v_mfma_f32_32x32x16_bf16 v[16:31], v[32:35], v[160:163], v[16:31]
    ds_read_b64_tr_b16 v[32:33], v12 offset:12288
    ds_read_b64_tr_b16 v[34:35], v12 offset:12544
    s_waitcnt lgkmcnt(6)
    v_mfma_f32_32x32x16_bf16 v[16:31], v[36:39], v[164:167], v[16:31]
    ds_read_b64_tr_b16 v[36:37], v12 offset:13312
    ds_read_b64_tr_b16 v[38:39], v12 offset:13568
    s_waitcnt lgkmcnt(6)
    v_mfma_f32_32x32x16_bf16 v[16:31], v[40:43], v[168:171], v[16:31]
    ds_read_b64_tr_b16 v[40:41], v12 offset:14336
    ds_read_b64_tr_b16 v[42:43], v12 offset:14592
    s_waitcnt lgkmcnt(6)
    v_mfma_f32_32x32x16_bf16 v[16:31], v[44:47], v[172:175], v[16:31]
    ds_read_b64_tr_b16 v[44:45], v12 offset:15360
    ds_read_b64_tr_b16 v[46:47], v12 offset:15616
    s_waitcnt lgkmcnt(6)
    v_mfma_f32_32x32x16_bf16 v[16:31], v[32:35], v[176:179], v[16:31]
    ds_read_b64_tr_b16 v[32:33], v12 offset:16384
    ds_read_b64_tr_b16 v[34:35], v12 offset:16640
    s_waitcnt lgkmcnt(6)
    v_mfma_f32_32x32x16_bf16 v[16:31], v[36:39], v[180:183], v[16:31]
    ds_read_b64_tr_b16 v[36:37], v12 offset:17408
    ds_read_b64_tr_b16 v[38:39], v12 offset:17664
    s_waitcnt lgkmcnt(6)
    v_mfma_f32_32x32x16_bf16 v[16:31], v[40:43], v[184:187], v[16:31]
    ds_read_b64_tr_b16 v[40:41], v12 offset:18432
    ds_read_b64_tr_b16 v[42:43], v12 offset:18688
    s_waitcnt lgkmcnt(6)
    v_mfma_f32_32x32x16_bf16 v[16:31], v[44:47], v[188:191], v[16:31]
    ds_read_b64_tr_b16 v[44:45], v12 offset:19456
    ds_read_b64_tr_b16 v[46:47], v12 offset:19712
    s_waitcnt lgkmcnt(6)
    v_mfma_f32_32x32x16_bf16 v[16:31], v[32:35], v[192:195], v[16:31]
    ds_read_b64_tr_b16 v[32:33], v12 offset:20480
    ds_read_b64_tr_b16 v[34:35], v12 offset:20736
    s_waitcnt lgkmcnt(6)
    v_mfma_f32_32x32x16_bf16 v[16:31], v[36:39], v[196:199], v[16:31]
    ds_read_b64_tr_b16 v[36:37], v12 offset:21504
    ds_read_b64_tr_b16 v[38:39], v12 offset:21760
    s_waitcnt lgkmcnt(6)
    v_mfma_f32_32x32x16_bf16 v[16:31], v[40:43], v[200:203], v[16:31]
    ds_read_b64_tr_b16 v[40:41], v12 offset:22528
    ds_read_b64_tr_b16 v[42:43], v12 offset:22784
    s_waitcnt lgkmcnt(6)
    v_mfma_f32_32x32x16_bf16 v[16:31], v[44:47], v[204:207], v[16:31]
    ds_read_b64_tr_b16 v[44:45], v12 offset:23552
    ds_read_b64_tr_b16 v[46:47], v12 offset:23808
    s_waitcnt lgkmcnt(6)
    v_mfma_f32_32x32x16_bf16 v[16:31], v[32:35], v[208:211], v[16:31]
    ds_read_b64_tr_b16 v[32:33], v12 offset:24576
    ds_read_b64_tr_b16 v[34:35], v12 offset:24832
    s_waitcnt lgkmcnt(6)
    v_mfma_f32_32x32x16_bf16 v[16:31], v[36:39], v[212:215], v[16:31]
    ds_read_b64_tr_b16 v[36:37], v12 offset:25600
    ds_read_b64_tr_b16 v[38:39], v12 offset:25856
    s_waitcnt lgkmcnt(6)
    v_mfma_f32_32x32x16_bf16 v[16:31], v[40:43], v[216:219], v[16:31]
    ds_read_b64_tr_b16 v[40:41], v12 offset:26624
    ds_read_b64_tr_b16 v[42:43], v12 offset:26880
    s_waitcnt lgkmcnt(6)
    v_mfma_f32_32x32x16_bf16 v[16:31], v[44:47], v[220:223], v[16:31]
    ds_read_b64_tr_b16 v[44:45], v12 offset:27648
    ds_read_b64_tr_b16 v[46:47], v12 offset:27904
    s_waitcnt lgkmcnt(6)
    v_mfma_f32_32x32x16_bf16 v[16:31], v[32:35], v[224:227], v[16:31]
    ds_read_b64_tr_b16 v[32:33], v12 offset:28672
    ds_read_b64_tr_b16 v[34:35], v12 offset:28928
    s_waitcnt lgkmcnt(6)
    v_mfma_f32_32x32x16_bf16 v[16:31], v[36:39], v[228:231], v[16:31]
    ds_read_b64_tr_b16 v[36:37], v12 offset:29696
    ds_read_b64_tr_b16 v[38:39], v12 offset:29952
    s_waitcnt lgkmcnt(6)
    v_mfma_f32_32x32x16_bf16 v[16:31], v[40:43], v[232:235], v[16:31]
    ds_read_b64_tr_b16 v[40:41], v12 offset:30720
    ds_read_b64_tr_b16 v[42:43], v12 offset:30976
    s_waitcnt lgkmcnt(6)
    v_mfma_f32_32x32x16_bf16 v[16:31], v[44:47], v[236:239], v[16:31]
    ds_read_b64_tr_b16 v[44:45], v12 offset:31744
    ds_read_b64_tr_b16 v[46:47], v12 offset:32000
    s_waitcnt lgkmcnt(6)
    v_mfma_f32_32x32x16_bf16 v[16:31], v[32:35], v[240:243], v[16:31]
    s_waitcnt lgkmcnt(4)
    v_mfma_f32_32x32x16_bf16 v[16:31], v[36:39], v[244:247], v[16:31]
    s_waitcnt lgkmcnt(2)
    v_mfma_f32_32x32x16_bf16 v[16:31], v[40:43], v[248:251], v[16:31]
    s_waitcnt lgkmcnt(0)
    v_mfma_f32_32x32x16_bf16 v[16:31], v[44:47], v[252:255], v[16:31]
    s_cmp_eq_u32 s5, 16
    s_nop 7
    s_nop 2
    s_cbranch_scc1 L1_epi_kv
    s_mov_b32 s30, 0x3eb8aa3b
    v_lshlrev_b32 v6, 10, v10
    v_lshl_add_u32 v6, v11, 3, v6
    s_lshl_b32 s7, s5, 6
    v_add_u32 v6, s7, v6
    v_mul_f32 v16, s30, v16
    v_mul_f32 v17, s30, v17
    v_mul_f32 v18, s30, v18
    v_mul_f32 v19, s30, v19
    v_cvt_pk_bf16_f32 v2, v16, v17
    v_cvt_pk_bf16_f32 v3, v18, v19
    buffer_store_dwordx2 v[2:3], v6, s[20:23], 0 offen offset:0
    s_nop 1
    v_mul_f32 v20, s30, v20
    v_mul_f32 v21, s30, v21
    v_mul_f32 v22, s30, v22
    v_mul_f32 v23, s30, v23
    v_cvt_pk_bf16_f32 v2, v20, v21
    v_cvt_pk_bf16_f32 v3, v22, v23
    buffer_store_dwordx2 v[2:3], v6, s[20:23], 0 offen offset:16
    s_nop 1
    v_mul_f32 v24, s30, v24
    v_mul_f32 v25, s30, v25
    v_mul_f32 v26, s30, v26
    v_mul_f32 v27, s30, v27
    v_cvt_pk_bf16_f32 v2, v24, v25
    v_cvt_pk_bf16_f32 v3, v26, v27
    buffer_store_dwordx2 v[2:3], v6, s[20:23], 0 offen offset:32
    s_nop 1
    v_mul_f32 v28, s30, v28
    v_mul_f32 v29, s30, v29
    v_mul_f32 v30, s30, v30
    v_mul_f32 v31, s30, v31
    v_cvt_pk_bf16_f32 v2, v28, v29
    v_cvt_pk_bf16_f32 v3, v30, v31
    buffer_store_dwordx2 v[2:3], v6, s[20:23], 0 offen offset:48
    s_nop 1
    s_nop 3
    s_branch L1_end
    s_nop 3
L1_epi_kv:
    v_lshlrev_b32 v6, 5, v10
    v_lshl_add_u32 v6, v11, 3, v6
    v_add_u32 v6, 0x200000, v6
    v_cvt_pk_bf16_f32 v2, v16, v17
    v_cvt_pk_bf16_f32 v3, v18, v19
    buffer_store_dwordx2 v[2:3], v6, s[20:23], 0 offen offset:0
    s_nop 1
    v_cvt_pk_bf16_f32 v2, v20, v21
    v_cvt_pk_bf16_f32 v3, v22, v23
    buffer_store_dwordx2 v[2:3], v6, s[20:23], 0 offen offset:16
    s_nop 1
    v_lshrrev_b32 v6, 4, v10
    v_lshlrev_b32 v6, 10, v6
    v_bfe_u32 v7, v10, 2, 1
    v_lshl_add_u32 v6, v7, 9, v6
    v_and_b32 v7, 3, v10
    v_lshl_add_u32 v6, v7, 1, v6
    v_bfe_u32 v7, v10, 3, 1
    v_lshl_add_u32 v6, v7, 3, v6
    v_lshl_add_u32 v6, v11, 6, v6
    v_add_u32 v6, 0x210000, v6
    v_cvt_pk_bf16_f32 v2, v24, v24
    buffer_store_short v2, v6, s[20:23], 0 offen offset:0
    v_cvt_pk_bf16_f32 v2, v25, v25
    buffer_store_short v2, v6, s[20:23], 0 offen offset:16
    v_cvt_pk_bf16_f32 v2, v26, v26
    buffer_store_short v2, v6, s[20:23], 0 offen offset:32
    v_cvt_pk_bf16_f32 v2, v27, v27
    buffer_store_short v2, v6, s[20:23], 0 offen offset:48
    v_cvt_pk_bf16_f32 v2, v28, v28
    buffer_store_short v2, v6, s[20:23], 0 offen offset:128
    v_cvt_pk_bf16_f32 v2, v29, v29
    buffer_store_short v2, v6, s[20:23], 0 offen offset:144
    v_cvt_pk_bf16_f32 v2, v30, v30
    buffer_store_short v2, v6, s[20:23], 0 offen offset:160
    v_cvt_pk_bf16_f32 v2, v31, v31
    buffer_store_short v2, v6, s[20:23], 0 offen offset:176
    v_lshrrev_b32 v6, 5, v0
    s_lshl_b32 s7, s4, 3
    v_add_u32 v6, s7, v6
    v_lshlrev_b32 v6, 10, v6
    v_and_b32 v7, 15, v0
    v_add_u32 v8, 16, v7
    v_bfe_u32 v9, v0, 4, 1
    v_lshl_add_u32 v8, v9, 5, v8
    v_lshl_add_u32 v6, v8, 4, v6
    v_add_u32 v6, 0x210000, v6
    v_mov_b32 v2, 0
    v_mov_b32 v3, 0x3f803f80
    v_cmp_eq_u32 vcc, 0, v7
    s_nop 1
    v_cndmask_b32 v2, v2, v3, vcc
    v_mov_b32 v3, v2
    v_mov_b32 v4, v2
    v_mov_b32 v5, v2
    buffer_store_dwordx4 v[2:5], v6, s[20:23], 0 offen
    s_nop 3
L1_end:
    s_endpgm
.globl k2_kernel
.p2align 8
.type k2_kernel,@function
k2_kernel:
    s_cmp_ge_u32 s2, 256
    s_cbranch_scc1 L2_end
    s_load_dwordx2 s[20:21], s[0:1], 88
    v_and_b32 v3, 31, v0
    v_bfe_u32 v74, v0, 5, 1
    v_lshrrev_b32 v75, 6, v0
    s_lshl_b32 s4, s2, 3
    v_add_u32 v75, s4, v75
    v_lshlrev_b32 v76, 10, v75
    v_lshl_add_u32 v76, v3, 5, v76
    v_lshl_add_u32 v77, v74, 4, v76
    v_lshlrev_b32 v1, 4, v0
    s_waitcnt lgkmcnt(0)
    s_mov_b32 s22, 16777216
    s_mov_b32 s23, 0x00020000
    buffer_load_dwordx4 v[4:7], v77, s[20:23], 0 offen offset:0
    v_add_u32 v2, 0x200000, v1
    s_mov_b32 s7, 0
    buffer_load_dwordx4 v[80:83], v2, s[20:23], s7 offen
    s_mov_b32 s7, 8192
    buffer_load_dwordx4 v[84:87], v2, s[20:23], s7 offen
    s_mov_b32 s7, 16384
    buffer_load_dwordx4 v[88:91], v2, s[20:23], s7 offen
    s_mov_b32 s7, 24576
    buffer_load_dwordx4 v[92:95], v2, s[20:23], s7 offen
    s_mov_b32 s7, 32768
    buffer_load_dwordx4 v[96:99], v2, s[20:23], s7 offen
    s_mov_b32 s7, 40960
    buffer_load_dwordx4 v[100:103], v2, s[20:23], s7 offen
    s_mov_b32 s7, 49152
    buffer_load_dwordx4 v[104:107], v2, s[20:23], s7 offen
    s_mov_b32 s7, 57344
    buffer_load_dwordx4 v[108:111], v2, s[20:23], s7 offen
    v_lshrrev_b32 v2, 5, v0
    v_lshlrev_b32 v2, 10, v2
    v_bfe_u32 v3, v0, 4, 1
    v_lshl_add_u32 v2, v3, 9, v2
    v_and_b32 v3, 15, v0
    v_lshl_add_u32 v2, v3, 4, v2
    v_add_u32 v2, 0x210000, v2
    s_mov_b32 s7, 0
    buffer_load_dwordx4 v[112:115], v2, s[20:23], s7 offen
    s_mov_b32 s7, 16384
    buffer_load_dwordx4 v[116:119], v2, s[20:23], s7 offen
    s_mov_b32 s7, 32768
    buffer_load_dwordx4 v[120:123], v2, s[20:23], s7 offen
    s_mov_b32 s7, 49152
    buffer_load_dwordx4 v[124:127], v2, s[20:23], s7 offen
    s_mov_b32 s7, 65536
    buffer_load_dwordx4 v[128:131], v2, s[20:23], s7 offen
    s_mov_b32 s7, 81920
    buffer_load_dwordx4 v[132:135], v2, s[20:23], s7 offen
    s_mov_b32 s7, 98304
    buffer_load_dwordx4 v[136:139], v2, s[20:23], s7 offen
    s_mov_b32 s7, 114688
    buffer_load_dwordx4 v[140:143], v2, s[20:23], s7 offen
    s_waitcnt vmcnt(15)
    ds_write_b128 v1, v[80:83] offset:0
    s_waitcnt vmcnt(14)
    ds_write_b128 v1, v[84:87] offset:8192
    s_waitcnt vmcnt(13)
    ds_write_b128 v1, v[88:91] offset:16384
    s_waitcnt vmcnt(12)
    ds_write_b128 v1, v[92:95] offset:24576
    s_waitcnt vmcnt(11)
    ds_write_b128 v1, v[96:99] offset:32768
    s_waitcnt vmcnt(10)
    ds_write_b128 v1, v[100:103] offset:40960
    s_waitcnt vmcnt(9)
    ds_write_b128 v1, v[104:107] offset:49152
    s_waitcnt vmcnt(8)
    ds_write_b128 v1, v[108:111] offset:57344
    v_add_u32 v3, 0x10000, v1
    s_waitcnt vmcnt(7)
    ds_write_b128 v3, v[112:115] offset:0
    s_waitcnt vmcnt(6)
    ds_write_b128 v3, v[116:119] offset:8192
    s_waitcnt vmcnt(5)
    ds_write_b128 v3, v[120:123] offset:16384
    s_waitcnt vmcnt(4)
    ds_write_b128 v3, v[124:127] offset:24576
    s_waitcnt vmcnt(3)
    ds_write_b128 v3, v[128:131] offset:32768
    s_waitcnt vmcnt(2)
    ds_write_b128 v3, v[132:135] offset:40960
    s_waitcnt vmcnt(1)
    ds_write_b128 v3, v[136:139] offset:49152
    s_waitcnt vmcnt(0)
    ds_write_b128 v3, v[140:143] offset:57344
    v_and_b32 v3, 31, v0
    v_lshlrev_b32 v1, 5, v3
    v_lshl_add_u32 v1, v74, 4, v1
    v_and_b32 v3, 15, v0
    v_lshlrev_b32 v2, 4, v3
    v_lshl_add_u32 v2, v74, 8, v2
    v_add_u32 v2, 0x10000, v2
    v_mov_b32 v72, 0
    v_mov_b32 v112, 0xff800000
    v_mov_b32 v79, 0xff800000
    v_and_b32 v3, 31, v0
    v_mov_b32 v8, 0
    v_mov_b32 v9, 0x3f803f80
    v_cmp_eq_u32 vcc, 16, v3
    s_nop 1
    v_cndmask_b32 v8, v8, v9, vcc
    v_mov_b32 v16, v8
    v_mov_b32 v17, v8
    v_mov_b32 v18, v8
    v_mov_b32 v19, v8
    v_mov_b32 v20, v8
    v_mov_b32 v21, v8
    v_mov_b32 v22, v8
    v_mov_b32 v23, v8
    v_mov_b32 v24, v8
    v_mov_b32 v25, v8
    v_mov_b32 v26, v8
    v_mov_b32 v27, v8
    v_mov_b32 v28, v8
    v_mov_b32 v29, v8
    v_mov_b32 v30, v8
    v_mov_b32 v31, v8
    v_mov_b32 v48, 0
    v_mov_b32 v49, 0
    v_mov_b32 v50, 0
    v_mov_b32 v51, 0
    v_mov_b32 v52, 0
    v_mov_b32 v53, 0
    v_mov_b32 v54, 0
    v_mov_b32 v55, 0
    v_mov_b32 v56, 0
    v_mov_b32 v57, 0
    v_mov_b32 v58, 0
    v_mov_b32 v59, 0
    v_mov_b32 v60, 0
    v_mov_b32 v61, 0
    v_mov_b32 v62, 0
    v_mov_b32 v63, 0
    v_mov_b32 v96, 0
    v_mov_b32 v97, 0
    v_mov_b32 v98, 0
    v_mov_b32 v99, 0
    v_mov_b32 v100, 0
    v_mov_b32 v101, 0
    v_mov_b32 v102, 0
    v_mov_b32 v103, 0
    v_mov_b32 v104, 0
    v_mov_b32 v105, 0
    v_mov_b32 v106, 0
    v_mov_b32 v107, 0
    v_mov_b32 v108, 0
    v_mov_b32 v109, 0
    v_mov_b32 v110, 0
    v_mov_b32 v111, 0
    s_mov_b32 s8, 0xffff
    s_mov_b32 s9, 0xffff
    s_waitcnt vmcnt(0) lgkmcnt(0)
    s_barrier
    ds_read_b128 v[8:11], v1
    s_mov_b64 exec, s[8:9]
    ds_read_b128 v[16:19], v2
    ds_read_b128 v[20:23], v2 offset:512
    s_mov_b64 exec, -1
    s_mov_b32 s7, 0
    s_nop 3
L2_loop:
    v_add_u32 v1, 1024, v1
    v_add_u32 v2, 1024, v2
    ds_read_b128 v[12:15], v1
    s_mov_b64 exec, s[8:9]
    ds_read_b128 v[24:27], v2
    ds_read_b128 v[28:31], v2 offset:512
    s_mov_b64 exec, -1
    s_waitcnt lgkmcnt(3)
    v_mfma_f32_32x32x16_bf16 v[32:47], v[8:11], v[4:7], v[96:111]
    s_nop 7
    s_nop 3
    v_max3_f32 v73, v32, v33, v34
    v_max3_f32 v78, v35, v36, v37
    v_max3_f32 v73, v73, v38, v39
    v_max3_f32 v78, v78, v40, v41
    v_max3_f32 v73, v73, v42, v43
    v_max3_f32 v78, v78, v44, v45
    v_max3_f32 v73, v73, v46, v47
    v_max_f32 v73, v73, v78
    v_mov_b32 v78, v73
    s_nop 1
    v_permlane32_swap_b32 v73, v78
    v_max_f32 v73, v73, v78
    v_cmp_gt_f32 vcc, v73, v112
    s_nop 3
    s_cbranch_vccz L2_skip0
    v_max_f32 v73, v73, v79
    v_sub_f32 v72, v72, v73
    v_sub_f32 v78, 0, v73
    v_exp_f32 v78, v78
    v_mov_b32 v112, 0x41000000
    v_mov_b32 v79, 0
    v_mul_f32 v48, v78, v48
    v_mul_f32 v49, v78, v49
    v_mul_f32 v50, v78, v50
    v_mul_f32 v51, v78, v51
    v_mul_f32 v52, v78, v52
    v_mul_f32 v53, v78, v53
    v_mul_f32 v54, v78, v54
    v_mul_f32 v55, v78, v55
    v_mul_f32 v56, v78, v56
    v_mul_f32 v57, v78, v57
    v_mul_f32 v58, v78, v58
    v_mul_f32 v59, v78, v59
    v_mul_f32 v60, v78, v60
    v_mul_f32 v61, v78, v61
    v_mul_f32 v62, v78, v62
    v_mul_f32 v63, v78, v63
    v_sub_f32 v32, v32, v73
    v_sub_f32 v33, v33, v73
    v_sub_f32 v34, v34, v73
    v_sub_f32 v35, v35, v73
    v_sub_f32 v36, v36, v73
    v_sub_f32 v37, v37, v73
    v_sub_f32 v38, v38, v73
    v_sub_f32 v39, v39, v73
    v_sub_f32 v40, v40, v73
    v_sub_f32 v41, v41, v73
    v_sub_f32 v42, v42, v73
    v_sub_f32 v43, v43, v73
    v_sub_f32 v44, v44, v73
    v_sub_f32 v45, v45, v73
    v_sub_f32 v46, v46, v73
    v_sub_f32 v47, v47, v73
    v_mov_b32 v96, v72
    v_mov_b32 v97, v72
    v_mov_b32 v98, v72
    v_mov_b32 v99, v72
    v_mov_b32 v100, v72
    v_mov_b32 v101, v72
    v_mov_b32 v102, v72
    v_mov_b32 v103, v72
    v_mov_b32 v104, v72
    v_mov_b32 v105, v72
    v_mov_b32 v106, v72
    v_mov_b32 v107, v72
    v_mov_b32 v108, v72
    v_mov_b32 v109, v72
    v_mov_b32 v110, v72
    v_mov_b32 v111, v72
    s_nop 3
L2_skip0:
    v_exp_f32 v32, v32
    v_exp_f32 v33, v33
    v_exp_f32 v34, v34
    v_exp_f32 v35, v35
    v_exp_f32 v36, v36
    v_exp_f32 v37, v37
    v_exp_f32 v38, v38
    v_exp_f32 v39, v39
    v_exp_f32 v40, v40
    v_exp_f32 v41, v41
    v_exp_f32 v42, v42
    v_exp_f32 v43, v43
    v_exp_f32 v44, v44
    v_exp_f32 v45, v45
    v_exp_f32 v46, v46
    v_exp_f32 v47, v47
    v_cvt_pk_bf16_f32 v64, v32, v33
    v_cvt_pk_bf16_f32 v65, v34, v35
    v_cvt_pk_bf16_f32 v66, v36, v37
    v_cvt_pk_bf16_f32 v67, v38, v39
    v_cvt_pk_bf16_f32 v68, v40, v41
    v_cvt_pk_bf16_f32 v69, v42, v43
    v_cvt_pk_bf16_f32 v70, v44, v45
    v_cvt_pk_bf16_f32 v71, v46, v47
    v_mfma_f32_32x32x16_bf16 v[48:63], v[16:19], v[64:67], v[48:63]
    s_nop 0
    v_mfma_f32_32x32x16_bf16 v[48:63], v[20:23], v[68:71], v[48:63]
    v_add_u32 v1, 1024, v1
    v_add_u32 v2, 1024, v2
    ds_read_b128 v[8:11], v1
    s_mov_b64 exec, s[8:9]
    ds_read_b128 v[16:19], v2
    ds_read_b128 v[20:23], v2 offset:512
    s_mov_b64 exec, -1
    s_waitcnt lgkmcnt(3)
    v_mfma_f32_32x32x16_bf16 v[32:47], v[12:15], v[4:7], v[96:111]
    s_nop 7
    s_nop 3
    v_max3_f32 v73, v32, v33, v34
    v_max3_f32 v78, v35, v36, v37
    v_max3_f32 v73, v73, v38, v39
    v_max3_f32 v78, v78, v40, v41
    v_max3_f32 v73, v73, v42, v43
    v_max3_f32 v78, v78, v44, v45
    v_max3_f32 v73, v73, v46, v47
    v_max_f32 v73, v73, v78
    v_mov_b32 v78, v73
    s_nop 1
    v_permlane32_swap_b32 v73, v78
    v_max_f32 v73, v73, v78
    v_cmp_gt_f32 vcc, v73, v112
    s_nop 3
    s_cbranch_vccz L2_skip1
    v_max_f32 v73, v73, v79
    v_sub_f32 v72, v72, v73
    v_sub_f32 v78, 0, v73
    v_exp_f32 v78, v78
    v_mov_b32 v112, 0x41000000
    v_mov_b32 v79, 0
    v_mul_f32 v48, v78, v48
    v_mul_f32 v49, v78, v49
    v_mul_f32 v50, v78, v50
    v_mul_f32 v51, v78, v51
    v_mul_f32 v52, v78, v52
    v_mul_f32 v53, v78, v53
    v_mul_f32 v54, v78, v54
    v_mul_f32 v55, v78, v55
    v_mul_f32 v56, v78, v56
    v_mul_f32 v57, v78, v57
    v_mul_f32 v58, v78, v58
    v_mul_f32 v59, v78, v59
    v_mul_f32 v60, v78, v60
    v_mul_f32 v61, v78, v61
    v_mul_f32 v62, v78, v62
    v_mul_f32 v63, v78, v63
    v_sub_f32 v32, v32, v73
    v_sub_f32 v33, v33, v73
    v_sub_f32 v34, v34, v73
    v_sub_f32 v35, v35, v73
    v_sub_f32 v36, v36, v73
    v_sub_f32 v37, v37, v73
    v_sub_f32 v38, v38, v73
    v_sub_f32 v39, v39, v73
    v_sub_f32 v40, v40, v73
    v_sub_f32 v41, v41, v73
    v_sub_f32 v42, v42, v73
    v_sub_f32 v43, v43, v73
    v_sub_f32 v44, v44, v73
    v_sub_f32 v45, v45, v73
    v_sub_f32 v46, v46, v73
    v_sub_f32 v47, v47, v73
    v_mov_b32 v96, v72
    v_mov_b32 v97, v72
    v_mov_b32 v98, v72
    v_mov_b32 v99, v72
    v_mov_b32 v100, v72
    v_mov_b32 v101, v72
    v_mov_b32 v102, v72
    v_mov_b32 v103, v72
    v_mov_b32 v104, v72
    v_mov_b32 v105, v72
    v_mov_b32 v106, v72
    v_mov_b32 v107, v72
    v_mov_b32 v108, v72
    v_mov_b32 v109, v72
    v_mov_b32 v110, v72
    v_mov_b32 v111, v72
    s_nop 3
L2_skip1:
    v_exp_f32 v32, v32
    v_exp_f32 v33, v33
    v_exp_f32 v34, v34
    v_exp_f32 v35, v35
    v_exp_f32 v36, v36
    v_exp_f32 v37, v37
    v_exp_f32 v38, v38
    v_exp_f32 v39, v39
    v_exp_f32 v40, v40
    v_exp_f32 v41, v41
    v_exp_f32 v42, v42
    v_exp_f32 v43, v43
    v_exp_f32 v44, v44
    v_exp_f32 v45, v45
    v_exp_f32 v46, v46
    v_exp_f32 v47, v47
    v_cvt_pk_bf16_f32 v64, v32, v33
    v_cvt_pk_bf16_f32 v65, v34, v35
    v_cvt_pk_bf16_f32 v66, v36, v37
    v_cvt_pk_bf16_f32 v67, v38, v39
    v_cvt_pk_bf16_f32 v68, v40, v41
    v_cvt_pk_bf16_f32 v69, v42, v43
    v_cvt_pk_bf16_f32 v70, v44, v45
    v_cvt_pk_bf16_f32 v71, v46, v47
    v_mfma_f32_32x32x16_bf16 v[48:63], v[24:27], v[64:67], v[48:63]
    s_nop 0
    v_mfma_f32_32x32x16_bf16 v[48:63], v[28:31], v[68:71], v[48:63]
    s_add_u32 s7, s7, 2
    s_cmp_lt_u32 s7, 64
    s_nop 7
    s_nop 1
    s_cbranch_scc1 L2_loop
    s_waitcnt lgkmcnt(0)
    v_mov_b32 v73, v56
    s_nop 1
    v_permlane32_swap_b32 v56, v73
    v_rcp_f32 v56, v56
    s_nop 0
    v_mul_f32 v48, v56, v48
    v_mul_f32 v49, v56, v49
    v_mul_f32 v50, v56, v50
    v_mul_f32 v51, v56, v51
    v_mul_f32 v52, v56, v52
    v_mul_f32 v53, v56, v53
    v_mul_f32 v54, v56, v54
    v_mul_f32 v55, v56, v55
    v_cvt_pk_bf16_f32 v64, v48, v49
    v_cvt_pk_bf16_f32 v65, v50, v51
    v_cvt_pk_bf16_f32 v66, v52, v53
    v_cvt_pk_bf16_f32 v67, v54, v55
    v_lshl_add_u32 v77, v74, 3, v76
    v_add_u32 v77, 0x300000, v77
    buffer_store_dwordx2 v[64:65], v77, s[20:23], 0 offen
    buffer_store_dwordx2 v[66:67], v77, s[20:23], 0 offen offset:16
    s_nop 3
L2_end:
    s_endpgm
.globl k3_kernel
.p2align 8
.type k3_kernel,@function
k3_kernel:
    s_cmp_ge_u32 s2, 256
    s_cbranch_scc1 L3_end
    s_load_dwordx2 s[8:9], s[0:1], 0
    s_load_dwordx2 s[12:13], s[0:1], 32
    s_load_dwordx2 s[20:21], s[0:1], 88
    s_and_b32 s4, s2, 15
    s_lshr_b32 s5, s2, 4
    v_lshrrev_b32 v2, 6, v0
    v_and_b32 v3, 31, v0
    v_bfe_u32 v11, v0, 5, 1
    s_lshl_b32 s6, s4, 7
    v_lshlrev_b32 v10, 5, v2
    v_add_u32 v10, v10, v3
    v_add_u32 v10, s6, v10
    v_lshlrev_b32 v6, 10, v10
    v_lshl_add_u32 v6, v11, 4, v6
    s_waitcnt lgkmcnt(0)
    s_mov_b32 s10, 2097152
    s_mov_b32 s11, 0x00020000
    s_mov_b32 s14, 524288
    s_mov_b32 s15, 0x00020000
    s_mov_b32 s22, 16777216
    s_mov_b32 s23, 0x00020000
    v_add_u32 v6, 0x300000, v6
    buffer_load_dwordx4 v[128:131], v6, s[20:23], 0 offen offset:0
    buffer_load_dwordx4 v[132:135], v6, s[20:23], 0 offen offset:32
    buffer_load_dwordx4 v[136:139], v6, s[20:23], 0 offen offset:64
    buffer_load_dwordx4 v[140:143], v6, s[20:23], 0 offen offset:96
    buffer_load_dwordx4 v[144:147], v6, s[20:23], 0 offen offset:128
    buffer_load_dwordx4 v[148:151], v6, s[20:23], 0 offen offset:160
    buffer_load_dwordx4 v[152:155], v6, s[20:23], 0 offen offset:192
    buffer_load_dwordx4 v[156:159], v6, s[20:23], 0 offen offset:224
    buffer_load_dwordx4 v[160:163], v6, s[20:23], 0 offen offset:256
    buffer_load_dwordx4 v[164:167], v6, s[20:23], 0 offen offset:288
    buffer_load_dwordx4 v[168:171], v6, s[20:23], 0 offen offset:320
    buffer_load_dwordx4 v[172:175], v6, s[20:23], 0 offen offset:352
    buffer_load_dwordx4 v[176:179], v6, s[20:23], 0 offen offset:384
    buffer_load_dwordx4 v[180:183], v6, s[20:23], 0 offen offset:416
    buffer_load_dwordx4 v[184:187], v6, s[20:23], 0 offen offset:448
    buffer_load_dwordx4 v[188:191], v6, s[20:23], 0 offen offset:480
    buffer_load_dwordx4 v[192:195], v6, s[20:23], 0 offen offset:512
    buffer_load_dwordx4 v[196:199], v6, s[20:23], 0 offen offset:544
    buffer_load_dwordx4 v[200:203], v6, s[20:23], 0 offen offset:576
    buffer_load_dwordx4 v[204:207], v6, s[20:23], 0 offen offset:608
    buffer_load_dwordx4 v[208:211], v6, s[20:23], 0 offen offset:640
    buffer_load_dwordx4 v[212:215], v6, s[20:23], 0 offen offset:672
    buffer_load_dwordx4 v[216:219], v6, s[20:23], 0 offen offset:704
    buffer_load_dwordx4 v[220:223], v6, s[20:23], 0 offen offset:736
    buffer_load_dwordx4 v[224:227], v6, s[20:23], 0 offen offset:768
    buffer_load_dwordx4 v[228:231], v6, s[20:23], 0 offen offset:800
    buffer_load_dwordx4 v[232:235], v6, s[20:23], 0 offen offset:832
    buffer_load_dwordx4 v[236:239], v6, s[20:23], 0 offen offset:864
    buffer_load_dwordx4 v[240:243], v6, s[20:23], 0 offen offset:896
    buffer_load_dwordx4 v[244:247], v6, s[20:23], 0 offen offset:928
    buffer_load_dwordx4 v[248:251], v6, s[20:23], 0 offen offset:960
    buffer_load_dwordx4 v[252:255], v6, s[20:23], 0 offen offset:992
    s_lshl_b32 s31, s5, 6
    v_lshrrev_b32 v7, 2, v0
    v_and_b32 v8, 3, v0
    v_lshlrev_b32 v9, 4, v0
    v_lshlrev_b32 v12, 10, v7
    v_lshl_add_u32 v12, v8, 4, v12
    v_add_u32 v12, s31, v12
    s_mov_b32 s7, 0
    buffer_load_dwordx4 v[32:35], v12, s[12:15], s7 offen
    s_mov_b32 s7, 65536
    buffer_load_dwordx4 v[36:39], v12, s[12:15], s7 offen
    s_mov_b32 s7, 131072
    buffer_load_dwordx4 v[40:43], v12, s[12:15], s7 offen
    s_mov_b32 s7, 196608
    buffer_load_dwordx4 v[44:47], v12, s[12:15], s7 offen
    s_mov_b32 s7, 262144
    buffer_load_dwordx4 v[48:51], v12, s[12:15], s7 offen
    s_mov_b32 s7, 327680
    buffer_load_dwordx4 v[52:55], v12, s[12:15], s7 offen
    s_mov_b32 s7, 393216
    buffer_load_dwordx4 v[56:59], v12, s[12:15], s7 offen
    s_mov_b32 s7, 458752
    buffer_load_dwordx4 v[60:63], v12, s[12:15], s7 offen
    s_waitcnt vmcnt(7)
    ds_write_b128 v9, v[32:35] offset:0
    s_waitcnt vmcnt(6)
    ds_write_b128 v9, v[36:39] offset:4096
    s_waitcnt vmcnt(5)
    ds_write_b128 v9, v[40:43] offset:8192
    s_waitcnt vmcnt(4)
    ds_write_b128 v9, v[44:47] offset:12288
    s_waitcnt vmcnt(3)
    ds_write_b128 v9, v[48:51] offset:16384
    s_waitcnt vmcnt(2)
    ds_write_b128 v9, v[52:55] offset:20480
    s_waitcnt vmcnt(1)
    ds_write_b128 v9, v[56:59] offset:24576
    s_waitcnt vmcnt(0)
    ds_write_b128 v9, v[60:63] offset:28672
    v_and_b32 v1, 63, v0
    v_lshrrev_b32 v2, 5, v1
    v_bfe_u32 v3, v1, 2, 2
    v_lshl_add_u32 v2, v2, 3, v3
    v_lshlrev_b32 v2, 6, v2
    v_bfe_u32 v3, v1, 4, 1
    v_lshl_add_u32 v2, v3, 5, v2
    v_and_b32 v3, 3, v1
    v_lshl_add_u32 v12, v3, 3, v2
    s_waitcnt vmcnt(0) lgkmcnt(0)
    s_barrier
    ds_read_b64_tr_b16 v[32:33], v12 offset:0
    ds_read_b64_tr_b16 v[34:35], v12 offset:256
    ds_read_b64_tr_b16 v[36:37], v12 offset:1024
    ds_read_b64_tr_b16 v[38:39], v12 offset:1280
    ds_read_b64_tr_b16 v[40:41], v12 offset:2048
    ds_read_b64_tr_b16 v[42:43], v12 offset:2304
    ds_read_b64_tr_b16 v[44:45], v12 offset:3072
    ds_read_b64_tr_b16 v[46:47], v12 offset:3328
    s_waitcnt lgkmcnt(6)
    v_mfma_f32_32x32x16_bf16 v[16:31], v[32:35], v[128:131], 0
    ds_read_b64_tr_b16 v[32:33], v12 offset:4096
    ds_read_b64_tr_b16 v[34:35], v12 offset:4352
    s_waitcnt lgkmcnt(6)
    v_mfma_f32_32x32x16_bf16 v[16:31], v[36:39], v[132:135], v[16:31]
    ds_read_b64_tr_b16 v[36:37], v12 offset:5120
    ds_read_b64_tr_b16 v[38:39], v12 offset:5376
    s_waitcnt lgkmcnt(6)
    v_mfma_f32_32x32x16_bf16 v[16:31], v[40:43], v[136:139], v[16:31]
    ds_read_b64_tr_b16 v[40:41], v12 offset:6144
    ds_read_b64_tr_b16 v[42:43], v12 offset:6400
    s_waitcnt lgkmcnt(6)
    v_mfma_f32_32x32x16_bf16 v[16:31], v[44:47], v[140:143], v[16:31]
    ds_read_b64_tr_b16 v[44:45], v12 offset:7168
    ds_read_b64_tr_b16 v[46:47], v12 offset:7424
    s_waitcnt lgkmcnt(6)
    v_mfma_f32_32x32x16_bf16 v[16:31], v[32:35], v[144:147], v[16:31]
    ds_read_b64_tr_b16 v[32:33], v12 offset:8192
    ds_read_b64_tr_b16 v[34:35], v12 offset:8448
    s_waitcnt lgkmcnt(6)
    v_mfma_f32_32x32x16_bf16 v[16:31], v[36:39], v[148:151], v[16:31]
    ds_read_b64_tr_b16 v[36:37], v12 offset:9216
    ds_read_b64_tr_b16 v[38:39], v12 offset:9472
    s_waitcnt lgkmcnt(6)
    v_mfma_f32_32x32x16_bf16 v[16:31], v[40:43], v[152:155], v[16:31]
    ds_read_b64_tr_b16 v[40:41], v12 offset:10240
    ds_read_b64_tr_b16 v[42:43], v12 offset:10496
    s_waitcnt lgkmcnt(6)
    v_mfma_f32_32x32x16_bf16 v[16:31], v[44:47], v[156:159], v[16:31]
    ds_read_b64_tr_b16 v[44:45], v12 offset:11264
    ds_read_b64_tr_b16 v[46:47], v12 offset:11520
    s_waitcnt lgkmcnt(6)
    v_mfma_f32_32x32x16_bf16 v[16:31], v[32:35], v[160:163], v[16:31]
    ds_read_b64_tr_b16 v[32:33], v12 offset:12288
    ds_read_b64_tr_b16 v[34:35], v12 offset:12544
    s_waitcnt lgkmcnt(6)
    v_mfma_f32_32x32x16_bf16 v[16:31], v[36:39], v[164:167], v[16:31]
    ds_read_b64_tr_b16 v[36:37], v12 offset:13312
    ds_read_b64_tr_b16 v[38:39], v12 offset:13568
    s_waitcnt lgkmcnt(6)
    v_mfma_f32_32x32x16_bf16 v[16:31], v[40:43], v[168:171], v[16:31]
    ds_read_b64_tr_b16 v[40:41], v12 offset:14336
    ds_read_b64_tr_b16 v[42:43], v12 offset:14592
    s_waitcnt lgkmcnt(6)
    v_mfma_f32_32x32x16_bf16 v[16:31], v[44:47], v[172:175], v[16:31]
    ds_read_b64_tr_b16 v[44:45], v12 offset:15360
    ds_read_b64_tr_b16 v[46:47], v12 offset:15616
    s_waitcnt lgkmcnt(6)
    v_mfma_f32_32x32x16_bf16 v[16:31], v[32:35], v[176:179], v[16:31]
    ds_read_b64_tr_b16 v[32:33], v12 offset:16384
    ds_read_b64_tr_b16 v[34:35], v12 offset:16640
    s_waitcnt lgkmcnt(6)
    v_mfma_f32_32x32x16_bf16 v[16:31], v[36:39], v[180:183], v[16:31]
    ds_read_b64_tr_b16 v[36:37], v12 offset:17408
    ds_read_b64_tr_b16 v[38:39], v12 offset:17664
    s_waitcnt lgkmcnt(6)
    v_mfma_f32_32x32x16_bf16 v[16:31], v[40:43], v[184:187], v[16:31]
    ds_read_b64_tr_b16 v[40:41], v12 offset:18432
    ds_read_b64_tr_b16 v[42:43], v12 offset:18688
    s_waitcnt lgkmcnt(6)
    v_mfma_f32_32x32x16_bf16 v[16:31], v[44:47], v[188:191], v[16:31]
    ds_read_b64_tr_b16 v[44:45], v12 offset:19456
    ds_read_b64_tr_b16 v[46:47], v12 offset:19712
    s_waitcnt lgkmcnt(6)
    v_mfma_f32_32x32x16_bf16 v[16:31], v[32:35], v[192:195], v[16:31]
    ds_read_b64_tr_b16 v[32:33], v12 offset:20480
    ds_read_b64_tr_b16 v[34:35], v12 offset:20736
    s_waitcnt lgkmcnt(6)
    v_mfma_f32_32x32x16_bf16 v[16:31], v[36:39], v[196:199], v[16:31]
    ds_read_b64_tr_b16 v[36:37], v12 offset:21504
    ds_read_b64_tr_b16 v[38:39], v12 offset:21760
    s_waitcnt lgkmcnt(6)
    v_mfma_f32_32x32x16_bf16 v[16:31], v[40:43], v[200:203], v[16:31]
    ds_read_b64_tr_b16 v[40:41], v12 offset:22528
    ds_read_b64_tr_b16 v[42:43], v12 offset:22784
    s_waitcnt lgkmcnt(6)
    v_mfma_f32_32x32x16_bf16 v[16:31], v[44:47], v[204:207], v[16:31]
    ds_read_b64_tr_b16 v[44:45], v12 offset:23552
    ds_read_b64_tr_b16 v[46:47], v12 offset:23808
    s_waitcnt lgkmcnt(6)
    v_mfma_f32_32x32x16_bf16 v[16:31], v[32:35], v[208:211], v[16:31]
    ds_read_b64_tr_b16 v[32:33], v12 offset:24576
    ds_read_b64_tr_b16 v[34:35], v12 offset:24832
    s_waitcnt lgkmcnt(6)
    v_mfma_f32_32x32x16_bf16 v[16:31], v[36:39], v[212:215], v[16:31]
    ds_read_b64_tr_b16 v[36:37], v12 offset:25600
    ds_read_b64_tr_b16 v[38:39], v12 offset:25856
    s_waitcnt lgkmcnt(6)
    v_mfma_f32_32x32x16_bf16 v[16:31], v[40:43], v[216:219], v[16:31]
    ds_read_b64_tr_b16 v[40:41], v12 offset:26624
    ds_read_b64_tr_b16 v[42:43], v12 offset:26880
    s_waitcnt lgkmcnt(6)
    v_mfma_f32_32x32x16_bf16 v[16:31], v[44:47], v[220:223], v[16:31]
    ds_read_b64_tr_b16 v[44:45], v12 offset:27648
    ds_read_b64_tr_b16 v[46:47], v12 offset:27904
    s_waitcnt lgkmcnt(6)
    v_mfma_f32_32x32x16_bf16 v[16:31], v[32:35], v[224:227], v[16:31]
    ds_read_b64_tr_b16 v[32:33], v12 offset:28672
    ds_read_b64_tr_b16 v[34:35], v12 offset:28928
    s_waitcnt lgkmcnt(6)
    v_mfma_f32_32x32x16_bf16 v[16:31], v[36:39], v[228:231], v[16:31]
    ds_read_b64_tr_b16 v[36:37], v12 offset:29696
    ds_read_b64_tr_b16 v[38:39], v12 offset:29952
    s_waitcnt lgkmcnt(6)
    v_mfma_f32_32x32x16_bf16 v[16:31], v[40:43], v[232:235], v[16:31]
    ds_read_b64_tr_b16 v[40:41], v12 offset:30720
    ds_read_b64_tr_b16 v[42:43], v12 offset:30976
    s_waitcnt lgkmcnt(6)
    v_mfma_f32_32x32x16_bf16 v[16:31], v[44:47], v[236:239], v[16:31]
    ds_read_b64_tr_b16 v[44:45], v12 offset:31744
    ds_read_b64_tr_b16 v[46:47], v12 offset:32000
    s_waitcnt lgkmcnt(6)
    v_mfma_f32_32x32x16_bf16 v[16:31], v[32:35], v[240:243], v[16:31]
    s_waitcnt lgkmcnt(4)
    v_mfma_f32_32x32x16_bf16 v[16:31], v[36:39], v[244:247], v[16:31]
    s_waitcnt lgkmcnt(2)
    v_mfma_f32_32x32x16_bf16 v[16:31], v[40:43], v[248:251], v[16:31]
    s_waitcnt lgkmcnt(0)
    v_mfma_f32_32x32x16_bf16 v[16:31], v[44:47], v[252:255], v[16:31]
    v_lshlrev_b32 v6, 10, v10
    v_lshl_add_u32 v6, v11, 3, v6
    s_lshl_b32 s7, s5, 6
    v_add_u32 v6, s7, v6
    v_mov_b32 v7, v6
    v_add_u32 v6, 0x500000, v6
    buffer_load_dwordx2 v[32:33], v7, s[8:11], 0 offen offset:0
    buffer_load_dwordx2 v[34:35], v7, s[8:11], 0 offen offset:16
    buffer_load_dwordx2 v[36:37], v7, s[8:11], 0 offen offset:32
    buffer_load_dwordx2 v[38:39], v7, s[8:11], 0 offen offset:48
    s_waitcnt vmcnt(3)
    v_lshlrev_b32 v2, 16, v32
    v_add_f32 v16, v2, v16
    v_and_b32 v2, 0xffff0000, v32
    v_add_f32 v17, v2, v17
    v_lshlrev_b32 v2, 16, v33
    v_add_f32 v18, v2, v18
    v_and_b32 v2, 0xffff0000, v33
    v_add_f32 v19, v2, v19
    v_cvt_pk_bf16_f32 v2, v16, v17
    v_cvt_pk_bf16_f32 v3, v18, v19
    buffer_store_dwordx2 v[2:3], v6, s[20:23], 0 offen offset:0
    s_nop 1
    s_waitcnt vmcnt(2)
    v_lshlrev_b32 v2, 16, v34
    v_add_f32 v20, v2, v20
    v_and_b32 v2, 0xffff0000, v34
    v_add_f32 v21, v2, v21
    v_lshlrev_b32 v2, 16, v35
    v_add_f32 v22, v2, v22
    v_and_b32 v2, 0xffff0000, v35
    v_add_f32 v23, v2, v23
    v_cvt_pk_bf16_f32 v2, v20, v21
    v_cvt_pk_bf16_f32 v3, v22, v23
    buffer_store_dwordx2 v[2:3], v6, s[20:23], 0 offen offset:16
    s_nop 1
    s_waitcnt vmcnt(1)
    v_lshlrev_b32 v2, 16, v36
    v_add_f32 v24, v2, v24
    v_and_b32 v2, 0xffff0000, v36
    v_add_f32 v25, v2, v25
    v_lshlrev_b32 v2, 16, v37
    v_add_f32 v26, v2, v26
    v_and_b32 v2, 0xffff0000, v37
    v_add_f32 v27, v2, v27
    v_cvt_pk_bf16_f32 v2, v24, v25
    v_cvt_pk_bf16_f32 v3, v26, v27
    buffer_store_dwordx2 v[2:3], v6, s[20:23], 0 offen offset:32
    s_nop 1
    s_waitcnt vmcnt(0)
    v_lshlrev_b32 v2, 16, v38
    v_add_f32 v28, v2, v28
    v_and_b32 v2, 0xffff0000, v38
    v_add_f32 v29, v2, v29
    v_lshlrev_b32 v2, 16, v39
    v_add_f32 v30, v2, v30
    v_and_b32 v2, 0xffff0000, v39
    v_add_f32 v31, v2, v31
    v_cvt_pk_bf16_f32 v2, v28, v29
    v_cvt_pk_bf16_f32 v3, v30, v31
    buffer_store_dwordx2 v[2:3], v6, s[20:23], 0 offen offset:48
    s_nop 1
    s_nop 3
L3_end:
    s_endpgm
.globl k4_kernel
.p2align 8
.type k4_kernel,@function
k4_kernel:
    s_cmp_ge_u32 s2, 256
    s_cbranch_scc1 L4_end
    s_load_dwordx2 s[12:13], s[0:1], 48
    s_load_dwordx2 s[16:17], s[0:1], 56
    s_load_dwordx2 s[20:21], s[0:1], 88
    s_and_b32 s4, s2, 15
    s_lshr_b32 s5, s2, 4
    v_lshrrev_b32 v2, 6, v0
    v_and_b32 v3, 31, v0
    v_bfe_u32 v11, v0, 5, 1
    s_lshl_b32 s6, s4, 7
    v_lshlrev_b32 v10, 5, v2
    v_add_u32 v10, v10, v3
    v_add_u32 v10, s6, v10
    v_lshlrev_b32 v6, 10, v10
    v_lshl_add_u32 v6, v11, 4, v6
    s_waitcnt lgkmcnt(0)
    s_mov_b32 s14, 1409024
    s_mov_b32 s15, 0x00020000
    s_mov_b32 s18, 1409024
    s_mov_b32 s19, 0x00020000
    s_mov_b32 s22, 16777216
    s_mov_b32 s23, 0x00020000
    v_add_u32 v6, 0x500000, v6
    buffer_load_dwordx4 v[128:131], v6, s[20:23], 0 offen offset:0
    buffer_load_dwordx4 v[132:135], v6, s[20:23], 0 offen offset:32
    buffer_load_dwordx4 v[136:139], v6, s[20:23], 0 offen offset:64
    buffer_load_dwordx4 v[140:143], v6, s[20:23], 0 offen offset:96
    buffer_load_dwordx4 v[144:147], v6, s[20:23], 0 offen offset:128
    buffer_load_dwordx4 v[148:151], v6, s[20:23], 0 offen offset:160
    buffer_load_dwordx4 v[152:155], v6, s[20:23], 0 offen offset:192
    buffer_load_dwordx4 v[156:159], v6, s[20:23], 0 offen offset:224
    buffer_load_dwordx4 v[160:163], v6, s[20:23], 0 offen offset:256
    buffer_load_dwordx4 v[164:167], v6, s[20:23], 0 offen offset:288
    buffer_load_dwordx4 v[168:171], v6, s[20:23], 0 offen offset:320
    buffer_load_dwordx4 v[172:175], v6, s[20:23], 0 offen offset:352
    buffer_load_dwordx4 v[176:179], v6, s[20:23], 0 offen offset:384
    buffer_load_dwordx4 v[180:183], v6, s[20:23], 0 offen offset:416
    buffer_load_dwordx4 v[184:187], v6, s[20:23], 0 offen offset:448
    buffer_load_dwordx4 v[188:191], v6, s[20:23], 0 offen offset:480
    buffer_load_dwordx4 v[192:195], v6, s[20:23], 0 offen offset:512
    buffer_load_dwordx4 v[196:199], v6, s[20:23], 0 offen offset:544
    buffer_load_dwordx4 v[200:203], v6, s[20:23], 0 offen offset:576
    buffer_load_dwordx4 v[204:207], v6, s[20:23], 0 offen offset:608
    buffer_load_dwordx4 v[208:211], v6, s[20:23], 0 offen offset:640
    buffer_load_dwordx4 v[212:215], v6, s[20:23], 0 offen offset:672
    buffer_load_dwordx4 v[216:219], v6, s[20:23], 0 offen offset:704
    buffer_load_dwordx4 v[220:223], v6, s[20:23], 0 offen offset:736
    buffer_load_dwordx4 v[224:227], v6, s[20:23], 0 offen offset:768
    buffer_load_dwordx4 v[228:231], v6, s[20:23], 0 offen offset:800
    buffer_load_dwordx4 v[232:235], v6, s[20:23], 0 offen offset:832
    buffer_load_dwordx4 v[236:239], v6, s[20:23], 0 offen offset:864
    buffer_load_dwordx4 v[240:243], v6, s[20:23], 0 offen offset:896
    buffer_load_dwordx4 v[244:247], v6, s[20:23], 0 offen offset:928
    buffer_load_dwordx4 v[248:251], v6, s[20:23], 0 offen offset:960
    buffer_load_dwordx4 v[252:255], v6, s[20:23], 0 offen offset:992
    s_waitcnt vmcnt(0)
    s_mov_b32 s30, 0x3f803f80
    v_mov_b32 v2, 0
    v_mov_b32 v6, 0
    v_mov_b32 v3, 0
    v_mov_b32 v7, 0
    v_mov_b32 v4, 0
    v_mov_b32 v8, 0
    v_mov_b32 v5, 0
    v_mov_b32 v9, 0
    v_dot2_f32_bf16 v2, v128, s30, v2
    v_dot2_f32_bf16 v6, v128, v128, v6
    v_dot2_f32_bf16 v3, v129, s30, v3
    v_dot2_f32_bf16 v7, v129, v129, v7
    v_dot2_f32_bf16 v4, v130, s30, v4
    v_dot2_f32_bf16 v8, v130, v130, v8
    v_dot2_f32_bf16 v5, v131, s30, v5
    v_dot2_f32_bf16 v9, v131, v131, v9
    v_dot2_f32_bf16 v2, v132, s30, v2
    v_dot2_f32_bf16 v6, v132, v132, v6
    v_dot2_f32_bf16 v3, v133, s30, v3
    v_dot2_f32_bf16 v7, v133, v133, v7
    v_dot2_f32_bf16 v4, v134, s30, v4
    v_dot2_f32_bf16 v8, v134, v134, v8
    v_dot2_f32_bf16 v5, v135, s30, v5
    v_dot2_f32_bf16 v9, v135, v135, v9
    v_dot2_f32_bf16 v2, v136, s30, v2
    v_dot2_f32_bf16 v6, v136, v136, v6
    v_dot2_f32_bf16 v3, v137, s30, v3
    v_dot2_f32_bf16 v7, v137, v137, v7
    v_dot2_f32_bf16 v4, v138, s30, v4
    v_dot2_f32_bf16 v8, v138, v138, v8
    v_dot2_f32_bf16 v5, v139, s30, v5
    v_dot2_f32_bf16 v9, v139, v139, v9
    v_dot2_f32_bf16 v2, v140, s30, v2
    v_dot2_f32_bf16 v6, v140, v140, v6
    v_dot2_f32_bf16 v3, v141, s30, v3
    v_dot2_f32_bf16 v7, v141, v141, v7
    v_dot2_f32_bf16 v4, v142, s30, v4
    v_dot2_f32_bf16 v8, v142, v142, v8
    v_dot2_f32_bf16 v5, v143, s30, v5
    v_dot2_f32_bf16 v9, v143, v143, v9
    v_dot2_f32_bf16 v2, v144, s30, v2
    v_dot2_f32_bf16 v6, v144, v144, v6
    v_dot2_f32_bf16 v3, v145, s30, v3
    v_dot2_f32_bf16 v7, v145, v145, v7
    v_dot2_f32_bf16 v4, v146, s30, v4
    v_dot2_f32_bf16 v8, v146, v146, v8
    v_dot2_f32_bf16 v5, v147, s30, v5
    v_dot2_f32_bf16 v9, v147, v147, v9
    v_dot2_f32_bf16 v2, v148, s30, v2
    v_dot2_f32_bf16 v6, v148, v148, v6
    v_dot2_f32_bf16 v3, v149, s30, v3
    v_dot2_f32_bf16 v7, v149, v149, v7
    v_dot2_f32_bf16 v4, v150, s30, v4
    v_dot2_f32_bf16 v8, v150, v150, v8
    v_dot2_f32_bf16 v5, v151, s30, v5
    v_dot2_f32_bf16 v9, v151, v151, v9
    v_dot2_f32_bf16 v2, v152, s30, v2
    v_dot2_f32_bf16 v6, v152, v152, v6
    v_dot2_f32_bf16 v3, v153, s30, v3
    v_dot2_f32_bf16 v7, v153, v153, v7
    v_dot2_f32_bf16 v4, v154, s30, v4
    v_dot2_f32_bf16 v8, v154, v154, v8
    v_dot2_f32_bf16 v5, v155, s30, v5
    v_dot2_f32_bf16 v9, v155, v155, v9
    v_dot2_f32_bf16 v2, v156, s30, v2
    v_dot2_f32_bf16 v6, v156, v156, v6
    v_dot2_f32_bf16 v3, v157, s30, v3
    v_dot2_f32_bf16 v7, v157, v157, v7
    v_dot2_f32_bf16 v4, v158, s30, v4
    v_dot2_f32_bf16 v8, v158, v158, v8
    v_dot2_f32_bf16 v5, v159, s30, v5
    v_dot2_f32_bf16 v9, v159, v159, v9
    v_dot2_f32_bf16 v2, v160, s30, v2
    v_dot2_f32_bf16 v6, v160, v160, v6
    v_dot2_f32_bf16 v3, v161, s30, v3
    v_dot2_f32_bf16 v7, v161, v161, v7
    v_dot2_f32_bf16 v4, v162, s30, v4
    v_dot2_f32_bf16 v8, v162, v162, v8
    v_dot2_f32_bf16 v5, v163, s30, v5
    v_dot2_f32_bf16 v9, v163, v163, v9
    v_dot2_f32_bf16 v2, v164, s30, v2
    v_dot2_f32_bf16 v6, v164, v164, v6
    v_dot2_f32_bf16 v3, v165, s30, v3
    v_dot2_f32_bf16 v7, v165, v165, v7
    v_dot2_f32_bf16 v4, v166, s30, v4
    v_dot2_f32_bf16 v8, v166, v166, v8
    v_dot2_f32_bf16 v5, v167, s30, v5
    v_dot2_f32_bf16 v9, v167, v167, v9
    v_dot2_f32_bf16 v2, v168, s30, v2
    v_dot2_f32_bf16 v6, v168, v168, v6
    v_dot2_f32_bf16 v3, v169, s30, v3
    v_dot2_f32_bf16 v7, v169, v169, v7
    v_dot2_f32_bf16 v4, v170, s30, v4
    v_dot2_f32_bf16 v8, v170, v170, v8
    v_dot2_f32_bf16 v5, v171, s30, v5
    v_dot2_f32_bf16 v9, v171, v171, v9
    v_dot2_f32_bf16 v2, v172, s30, v2
    v_dot2_f32_bf16 v6, v172, v172, v6
    v_dot2_f32_bf16 v3, v173, s30, v3
    v_dot2_f32_bf16 v7, v173, v173, v7
    v_dot2_f32_bf16 v4, v174, s30, v4
    v_dot2_f32_bf16 v8, v174, v174, v8
    v_dot2_f32_bf16 v5, v175, s30, v5
    v_dot2_f32_bf16 v9, v175, v175, v9
    v_dot2_f32_bf16 v2, v176, s30, v2
    v_dot2_f32_bf16 v6, v176, v176, v6
    v_dot2_f32_bf16 v3, v177, s30, v3
    v_dot2_f32_bf16 v7, v177, v177, v7
    v_dot2_f32_bf16 v4, v178, s30, v4
    v_dot2_f32_bf16 v8, v178, v178, v8
    v_dot2_f32_bf16 v5, v179, s30, v5
    v_dot2_f32_bf16 v9, v179, v179, v9
    v_dot2_f32_bf16 v2, v180, s30, v2
    v_dot2_f32_bf16 v6, v180, v180, v6
    v_dot2_f32_bf16 v3, v181, s30, v3
    v_dot2_f32_bf16 v7, v181, v181, v7
    v_dot2_f32_bf16 v4, v182, s30, v4
    v_dot2_f32_bf16 v8, v182, v182, v8
    v_dot2_f32_bf16 v5, v183, s30, v5
    v_dot2_f32_bf16 v9, v183, v183, v9
    v_dot2_f32_bf16 v2, v184, s30, v2
    v_dot2_f32_bf16 v6, v184, v184, v6
    v_dot2_f32_bf16 v3, v185, s30, v3
    v_dot2_f32_bf16 v7, v185, v185, v7
    v_dot2_f32_bf16 v4, v186, s30, v4
    v_dot2_f32_bf16 v8, v186, v186, v8
    v_dot2_f32_bf16 v5, v187, s30, v5
    v_dot2_f32_bf16 v9, v187, v187, v9
    v_dot2_f32_bf16 v2, v188, s30, v2
    v_dot2_f32_bf16 v6, v188, v188, v6
    v_dot2_f32_bf16 v3, v189, s30, v3
    v_dot2_f32_bf16 v7, v189, v189, v7
    v_dot2_f32_bf16 v4, v190, s30, v4
    v_dot2_f32_bf16 v8, v190, v190, v8
    v_dot2_f32_bf16 v5, v191, s30, v5
    v_dot2_f32_bf16 v9, v191, v191, v9
    v_dot2_f32_bf16 v2, v192, s30, v2
    v_dot2_f32_bf16 v6, v192, v192, v6
    v_dot2_f32_bf16 v3, v193, s30, v3
    v_dot2_f32_bf16 v7, v193, v193, v7
    v_dot2_f32_bf16 v4, v194, s30, v4
    v_dot2_f32_bf16 v8, v194, v194, v8
    v_dot2_f32_bf16 v5, v195, s30, v5
    v_dot2_f32_bf16 v9, v195, v195, v9
    v_dot2_f32_bf16 v2, v196, s30, v2
    v_dot2_f32_bf16 v6, v196, v196, v6
    v_dot2_f32_bf16 v3, v197, s30, v3
    v_dot2_f32_bf16 v7, v197, v197, v7
    v_dot2_f32_bf16 v4, v198, s30, v4
    v_dot2_f32_bf16 v8, v198, v198, v8
    v_dot2_f32_bf16 v5, v199, s30, v5
    v_dot2_f32_bf16 v9, v199, v199, v9
    v_dot2_f32_bf16 v2, v200, s30, v2
    v_dot2_f32_bf16 v6, v200, v200, v6
    v_dot2_f32_bf16 v3, v201, s30, v3
    v_dot2_f32_bf16 v7, v201, v201, v7
    v_dot2_f32_bf16 v4, v202, s30, v4
    v_dot2_f32_bf16 v8, v202, v202, v8
    v_dot2_f32_bf16 v5, v203, s30, v5
    v_dot2_f32_bf16 v9, v203, v203, v9
    v_dot2_f32_bf16 v2, v204, s30, v2
    v_dot2_f32_bf16 v6, v204, v204, v6
    v_dot2_f32_bf16 v3, v205, s30, v3
    v_dot2_f32_bf16 v7, v205, v205, v7
    v_dot2_f32_bf16 v4, v206, s30, v4
    v_dot2_f32_bf16 v8, v206, v206, v8
    v_dot2_f32_bf16 v5, v207, s30, v5
    v_dot2_f32_bf16 v9, v207, v207, v9
    v_dot2_f32_bf16 v2, v208, s30, v2
    v_dot2_f32_bf16 v6, v208, v208, v6
    v_dot2_f32_bf16 v3, v209, s30, v3
    v_dot2_f32_bf16 v7, v209, v209, v7
    v_dot2_f32_bf16 v4, v210, s30, v4
    v_dot2_f32_bf16 v8, v210, v210, v8
    v_dot2_f32_bf16 v5, v211, s30, v5
    v_dot2_f32_bf16 v9, v211, v211, v9
    v_dot2_f32_bf16 v2, v212, s30, v2
    v_dot2_f32_bf16 v6, v212, v212, v6
    v_dot2_f32_bf16 v3, v213, s30, v3
    v_dot2_f32_bf16 v7, v213, v213, v7
    v_dot2_f32_bf16 v4, v214, s30, v4
    v_dot2_f32_bf16 v8, v214, v214, v8
    v_dot2_f32_bf16 v5, v215, s30, v5
    v_dot2_f32_bf16 v9, v215, v215, v9
    v_dot2_f32_bf16 v2, v216, s30, v2
    v_dot2_f32_bf16 v6, v216, v216, v6
    v_dot2_f32_bf16 v3, v217, s30, v3
    v_dot2_f32_bf16 v7, v217, v217, v7
    v_dot2_f32_bf16 v4, v218, s30, v4
    v_dot2_f32_bf16 v8, v218, v218, v8
    v_dot2_f32_bf16 v5, v219, s30, v5
    v_dot2_f32_bf16 v9, v219, v219, v9
    v_dot2_f32_bf16 v2, v220, s30, v2
    v_dot2_f32_bf16 v6, v220, v220, v6
    v_dot2_f32_bf16 v3, v221, s30, v3
    v_dot2_f32_bf16 v7, v221, v221, v7
    v_dot2_f32_bf16 v4, v222, s30, v4
    v_dot2_f32_bf16 v8, v222, v222, v8
    v_dot2_f32_bf16 v5, v223, s30, v5
    v_dot2_f32_bf16 v9, v223, v223, v9
    v_dot2_f32_bf16 v2, v224, s30, v2
    v_dot2_f32_bf16 v6, v224, v224, v6
    v_dot2_f32_bf16 v3, v225, s30, v3
    v_dot2_f32_bf16 v7, v225, v225, v7
    v_dot2_f32_bf16 v4, v226, s30, v4
    v_dot2_f32_bf16 v8, v226, v226, v8
    v_dot2_f32_bf16 v5, v227, s30, v5
    v_dot2_f32_bf16 v9, v227, v227, v9
    v_dot2_f32_bf16 v2, v228, s30, v2
    v_dot2_f32_bf16 v6, v228, v228, v6
    v_dot2_f32_bf16 v3, v229, s30, v3
    v_dot2_f32_bf16 v7, v229, v229, v7
    v_dot2_f32_bf16 v4, v230, s30, v4
    v_dot2_f32_bf16 v8, v230, v230, v8
    v_dot2_f32_bf16 v5, v231, s30, v5
    v_dot2_f32_bf16 v9, v231, v231, v9
    v_dot2_f32_bf16 v2, v232, s30, v2
    v_dot2_f32_bf16 v6, v232, v232, v6
    v_dot2_f32_bf16 v3, v233, s30, v3
    v_dot2_f32_bf16 v7, v233, v233, v7
    v_dot2_f32_bf16 v4, v234, s30, v4
    v_dot2_f32_bf16 v8, v234, v234, v8
    v_dot2_f32_bf16 v5, v235, s30, v5
    v_dot2_f32_bf16 v9, v235, v235, v9
    v_dot2_f32_bf16 v2, v236, s30, v2
    v_dot2_f32_bf16 v6, v236, v236, v6
    v_dot2_f32_bf16 v3, v237, s30, v3
    v_dot2_f32_bf16 v7, v237, v237, v7
    v_dot2_f32_bf16 v4, v238, s30, v4
    v_dot2_f32_bf16 v8, v238, v238, v8
    v_dot2_f32_bf16 v5, v239, s30, v5
    v_dot2_f32_bf16 v9, v239, v239, v9
    v_dot2_f32_bf16 v2, v240, s30, v2
    v_dot2_f32_bf16 v6, v240, v240, v6
    v_dot2_f32_bf16 v3, v241, s30, v3
    v_dot2_f32_bf16 v7, v241, v241, v7
    v_dot2_f32_bf16 v4, v242, s30, v4
    v_dot2_f32_bf16 v8, v242, v242, v8
    v_dot2_f32_bf16 v5, v243, s30, v5
    v_dot2_f32_bf16 v9, v243, v243, v9
    v_dot2_f32_bf16 v2, v244, s30, v2
    v_dot2_f32_bf16 v6, v244, v244, v6
    v_dot2_f32_bf16 v3, v245, s30, v3
    v_dot2_f32_bf16 v7, v245, v245, v7
    v_dot2_f32_bf16 v4, v246, s30, v4
    v_dot2_f32_bf16 v8, v246, v246, v8
    v_dot2_f32_bf16 v5, v247, s30, v5
    v_dot2_f32_bf16 v9, v247, v247, v9
    v_dot2_f32_bf16 v2, v248, s30, v2
    v_dot2_f32_bf16 v6, v248, v248, v6
    v_dot2_f32_bf16 v3, v249, s30, v3
    v_dot2_f32_bf16 v7, v249, v249, v7
    v_dot2_f32_bf16 v4, v250, s30, v4
    v_dot2_f32_bf16 v8, v250, v250, v8
    v_dot2_f32_bf16 v5, v251, s30, v5
    v_dot2_f32_bf16 v9, v251, v251, v9
    v_dot2_f32_bf16 v2, v252, s30, v2
    v_dot2_f32_bf16 v6, v252, v252, v6
    v_dot2_f32_bf16 v3, v253, s30, v3
    v_dot2_f32_bf16 v7, v253, v253, v7
    v_dot2_f32_bf16 v4, v254, s30, v4
    v_dot2_f32_bf16 v8, v254, v254, v8
    v_dot2_f32_bf16 v5, v255, s30, v5
    v_dot2_f32_bf16 v9, v255, v255, v9
    v_add_f32 v2, v2, v3
    v_add_f32 v4, v4, v5
    v_add_f32 v6, v6, v7
    v_add_f32 v8, v8, v9
    v_add_f32 v2, v2, v4
    v_add_f32 v6, v6, v8
    v_mov_b32 v3, v2
    v_mov_b32 v7, v6
    s_nop 0
    v_permlane32_swap_b32 v2, v3
    v_permlane32_swap_b32 v6, v7
    v_add_f32 v2, v2, v3
    v_add_f32 v6, v6, v7
    v_mul_f32 v2, 0x3b000000, v2
    v_mul_f32 v6, 0x3b000000, v6
    v_mul_f32 v3, v2, v2
    v_sub_f32 v6, v6, v3
    v_max_f32 v6, 0, v6
    v_add_f32 v6, 0x3727c5ac, v6
    v_rsq_f32 v6, v6
    s_nop 0
    v_mul_f32 v7, v2, v6
    v_sub_f32 v7, 0, v7
    v_lshlrev_b32 v2, 16, v128
    v_and_b32 v3, 0xffff0000, v128
    v_fma_f32 v2, v2, v6, v7
    v_fma_f32 v3, v3, v6, v7
    v_cvt_pk_bf16_f32 v128, v2, v3
    v_lshlrev_b32 v2, 16, v129
    v_and_b32 v3, 0xffff0000, v129
    v_fma_f32 v2, v2, v6, v7
    v_fma_f32 v3, v3, v6, v7
    v_cvt_pk_bf16_f32 v129, v2, v3
    v_lshlrev_b32 v2, 16, v130
    v_and_b32 v3, 0xffff0000, v130
    v_fma_f32 v2, v2, v6, v7
    v_fma_f32 v3, v3, v6, v7
    v_cvt_pk_bf16_f32 v130, v2, v3
    v_lshlrev_b32 v2, 16, v131
    v_and_b32 v3, 0xffff0000, v131
    v_fma_f32 v2, v2, v6, v7
    v_fma_f32 v3, v3, v6, v7
    v_cvt_pk_bf16_f32 v131, v2, v3
    v_lshlrev_b32 v2, 16, v132
    v_and_b32 v3, 0xffff0000, v132
    v_fma_f32 v2, v2, v6, v7
    v_fma_f32 v3, v3, v6, v7
    v_cvt_pk_bf16_f32 v132, v2, v3
    v_lshlrev_b32 v2, 16, v133
    v_and_b32 v3, 0xffff0000, v133
    v_fma_f32 v2, v2, v6, v7
    v_fma_f32 v3, v3, v6, v7
    v_cvt_pk_bf16_f32 v133, v2, v3
    v_lshlrev_b32 v2, 16, v134
    v_and_b32 v3, 0xffff0000, v134
    v_fma_f32 v2, v2, v6, v7
    v_fma_f32 v3, v3, v6, v7
    v_cvt_pk_bf16_f32 v134, v2, v3
    v_lshlrev_b32 v2, 16, v135
    v_and_b32 v3, 0xffff0000, v135
    v_fma_f32 v2, v2, v6, v7
    v_fma_f32 v3, v3, v6, v7
    v_cvt_pk_bf16_f32 v135, v2, v3
    v_lshlrev_b32 v2, 16, v136
    v_and_b32 v3, 0xffff0000, v136
    v_fma_f32 v2, v2, v6, v7
    v_fma_f32 v3, v3, v6, v7
    v_cvt_pk_bf16_f32 v136, v2, v3
    v_lshlrev_b32 v2, 16, v137
    v_and_b32 v3, 0xffff0000, v137
    v_fma_f32 v2, v2, v6, v7
    v_fma_f32 v3, v3, v6, v7
    v_cvt_pk_bf16_f32 v137, v2, v3
    v_lshlrev_b32 v2, 16, v138
    v_and_b32 v3, 0xffff0000, v138
    v_fma_f32 v2, v2, v6, v7
    v_fma_f32 v3, v3, v6, v7
    v_cvt_pk_bf16_f32 v138, v2, v3
    v_lshlrev_b32 v2, 16, v139
    v_and_b32 v3, 0xffff0000, v139
    v_fma_f32 v2, v2, v6, v7
    v_fma_f32 v3, v3, v6, v7
    v_cvt_pk_bf16_f32 v139, v2, v3
    v_lshlrev_b32 v2, 16, v140
    v_and_b32 v3, 0xffff0000, v140
    v_fma_f32 v2, v2, v6, v7
    v_fma_f32 v3, v3, v6, v7
    v_cvt_pk_bf16_f32 v140, v2, v3
    v_lshlrev_b32 v2, 16, v141
    v_and_b32 v3, 0xffff0000, v141
    v_fma_f32 v2, v2, v6, v7
    v_fma_f32 v3, v3, v6, v7
    v_cvt_pk_bf16_f32 v141, v2, v3
    v_lshlrev_b32 v2, 16, v142
    v_and_b32 v3, 0xffff0000, v142
    v_fma_f32 v2, v2, v6, v7
    v_fma_f32 v3, v3, v6, v7
    v_cvt_pk_bf16_f32 v142, v2, v3
    v_lshlrev_b32 v2, 16, v143
    v_and_b32 v3, 0xffff0000, v143
    v_fma_f32 v2, v2, v6, v7
    v_fma_f32 v3, v3, v6, v7
    v_cvt_pk_bf16_f32 v143, v2, v3
    v_lshlrev_b32 v2, 16, v144
    v_and_b32 v3, 0xffff0000, v144
    v_fma_f32 v2, v2, v6, v7
    v_fma_f32 v3, v3, v6, v7
    v_cvt_pk_bf16_f32 v144, v2, v3
    v_lshlrev_b32 v2, 16, v145
    v_and_b32 v3, 0xffff0000, v145
    v_fma_f32 v2, v2, v6, v7
    v_fma_f32 v3, v3, v6, v7
    v_cvt_pk_bf16_f32 v145, v2, v3
    v_lshlrev_b32 v2, 16, v146
    v_and_b32 v3, 0xffff0000, v146
    v_fma_f32 v2, v2, v6, v7
    v_fma_f32 v3, v3, v6, v7
    v_cvt_pk_bf16_f32 v146, v2, v3
    v_lshlrev_b32 v2, 16, v147
    v_and_b32 v3, 0xffff0000, v147
    v_fma_f32 v2, v2, v6, v7
    v_fma_f32 v3, v3, v6, v7
    v_cvt_pk_bf16_f32 v147, v2, v3
    v_lshlrev_b32 v2, 16, v148
    v_and_b32 v3, 0xffff0000, v148
    v_fma_f32 v2, v2, v6, v7
    v_fma_f32 v3, v3, v6, v7
    v_cvt_pk_bf16_f32 v148, v2, v3
    v_lshlrev_b32 v2, 16, v149
    v_and_b32 v3, 0xffff0000, v149
    v_fma_f32 v2, v2, v6, v7
    v_fma_f32 v3, v3, v6, v7
    v_cvt_pk_bf16_f32 v149, v2, v3
    v_lshlrev_b32 v2, 16, v150
    v_and_b32 v3, 0xffff0000, v150
    v_fma_f32 v2, v2, v6, v7
    v_fma_f32 v3, v3, v6, v7
    v_cvt_pk_bf16_f32 v150, v2, v3
    v_lshlrev_b32 v2, 16, v151
    v_and_b32 v3, 0xffff0000, v151
    v_fma_f32 v2, v2, v6, v7
    v_fma_f32 v3, v3, v6, v7
    v_cvt_pk_bf16_f32 v151, v2, v3
    v_lshlrev_b32 v2, 16, v152
    v_and_b32 v3, 0xffff0000, v152
    v_fma_f32 v2, v2, v6, v7
    v_fma_f32 v3, v3, v6, v7
    v_cvt_pk_bf16_f32 v152, v2, v3
    v_lshlrev_b32 v2, 16, v153
    v_and_b32 v3, 0xffff0000, v153
    v_fma_f32 v2, v2, v6, v7
    v_fma_f32 v3, v3, v6, v7
    v_cvt_pk_bf16_f32 v153, v2, v3
    v_lshlrev_b32 v2, 16, v154
    v_and_b32 v3, 0xffff0000, v154
    v_fma_f32 v2, v2, v6, v7
    v_fma_f32 v3, v3, v6, v7
    v_cvt_pk_bf16_f32 v154, v2, v3
    v_lshlrev_b32 v2, 16, v155
    v_and_b32 v3, 0xffff0000, v155
    v_fma_f32 v2, v2, v6, v7
    v_fma_f32 v3, v3, v6, v7
    v_cvt_pk_bf16_f32 v155, v2, v3
    v_lshlrev_b32 v2, 16, v156
    v_and_b32 v3, 0xffff0000, v156
    v_fma_f32 v2, v2, v6, v7
    v_fma_f32 v3, v3, v6, v7
    v_cvt_pk_bf16_f32 v156, v2, v3
    v_lshlrev_b32 v2, 16, v157
    v_and_b32 v3, 0xffff0000, v157
    v_fma_f32 v2, v2, v6, v7
    v_fma_f32 v3, v3, v6, v7
    v_cvt_pk_bf16_f32 v157, v2, v3
    v_lshlrev_b32 v2, 16, v158
    v_and_b32 v3, 0xffff0000, v158
    v_fma_f32 v2, v2, v6, v7
    v_fma_f32 v3, v3, v6, v7
    v_cvt_pk_bf16_f32 v158, v2, v3
    v_lshlrev_b32 v2, 16, v159
    v_and_b32 v3, 0xffff0000, v159
    v_fma_f32 v2, v2, v6, v7
    v_fma_f32 v3, v3, v6, v7
    v_cvt_pk_bf16_f32 v159, v2, v3
    v_lshlrev_b32 v2, 16, v160
    v_and_b32 v3, 0xffff0000, v160
    v_fma_f32 v2, v2, v6, v7
    v_fma_f32 v3, v3, v6, v7
    v_cvt_pk_bf16_f32 v160, v2, v3
    v_lshlrev_b32 v2, 16, v161
    v_and_b32 v3, 0xffff0000, v161
    v_fma_f32 v2, v2, v6, v7
    v_fma_f32 v3, v3, v6, v7
    v_cvt_pk_bf16_f32 v161, v2, v3
    v_lshlrev_b32 v2, 16, v162
    v_and_b32 v3, 0xffff0000, v162
    v_fma_f32 v2, v2, v6, v7
    v_fma_f32 v3, v3, v6, v7
    v_cvt_pk_bf16_f32 v162, v2, v3
    v_lshlrev_b32 v2, 16, v163
    v_and_b32 v3, 0xffff0000, v163
    v_fma_f32 v2, v2, v6, v7
    v_fma_f32 v3, v3, v6, v7
    v_cvt_pk_bf16_f32 v163, v2, v3
    v_lshlrev_b32 v2, 16, v164
    v_and_b32 v3, 0xffff0000, v164
    v_fma_f32 v2, v2, v6, v7
    v_fma_f32 v3, v3, v6, v7
    v_cvt_pk_bf16_f32 v164, v2, v3
    v_lshlrev_b32 v2, 16, v165
    v_and_b32 v3, 0xffff0000, v165
    v_fma_f32 v2, v2, v6, v7
    v_fma_f32 v3, v3, v6, v7
    v_cvt_pk_bf16_f32 v165, v2, v3
    v_lshlrev_b32 v2, 16, v166
    v_and_b32 v3, 0xffff0000, v166
    v_fma_f32 v2, v2, v6, v7
    v_fma_f32 v3, v3, v6, v7
    v_cvt_pk_bf16_f32 v166, v2, v3
    v_lshlrev_b32 v2, 16, v167
    v_and_b32 v3, 0xffff0000, v167
    v_fma_f32 v2, v2, v6, v7
    v_fma_f32 v3, v3, v6, v7
    v_cvt_pk_bf16_f32 v167, v2, v3
    v_lshlrev_b32 v2, 16, v168
    v_and_b32 v3, 0xffff0000, v168
    v_fma_f32 v2, v2, v6, v7
    v_fma_f32 v3, v3, v6, v7
    v_cvt_pk_bf16_f32 v168, v2, v3
    v_lshlrev_b32 v2, 16, v169
    v_and_b32 v3, 0xffff0000, v169
    v_fma_f32 v2, v2, v6, v7
    v_fma_f32 v3, v3, v6, v7
    v_cvt_pk_bf16_f32 v169, v2, v3
    v_lshlrev_b32 v2, 16, v170
    v_and_b32 v3, 0xffff0000, v170
    v_fma_f32 v2, v2, v6, v7
    v_fma_f32 v3, v3, v6, v7
    v_cvt_pk_bf16_f32 v170, v2, v3
    v_lshlrev_b32 v2, 16, v171
    v_and_b32 v3, 0xffff0000, v171
    v_fma_f32 v2, v2, v6, v7
    v_fma_f32 v3, v3, v6, v7
    v_cvt_pk_bf16_f32 v171, v2, v3
    v_lshlrev_b32 v2, 16, v172
    v_and_b32 v3, 0xffff0000, v172
    v_fma_f32 v2, v2, v6, v7
    v_fma_f32 v3, v3, v6, v7
    v_cvt_pk_bf16_f32 v172, v2, v3
    v_lshlrev_b32 v2, 16, v173
    v_and_b32 v3, 0xffff0000, v173
    v_fma_f32 v2, v2, v6, v7
    v_fma_f32 v3, v3, v6, v7
    v_cvt_pk_bf16_f32 v173, v2, v3
    v_lshlrev_b32 v2, 16, v174
    v_and_b32 v3, 0xffff0000, v174
    v_fma_f32 v2, v2, v6, v7
    v_fma_f32 v3, v3, v6, v7
    v_cvt_pk_bf16_f32 v174, v2, v3
    v_lshlrev_b32 v2, 16, v175
    v_and_b32 v3, 0xffff0000, v175
    v_fma_f32 v2, v2, v6, v7
    v_fma_f32 v3, v3, v6, v7
    v_cvt_pk_bf16_f32 v175, v2, v3
    v_lshlrev_b32 v2, 16, v176
    v_and_b32 v3, 0xffff0000, v176
    v_fma_f32 v2, v2, v6, v7
    v_fma_f32 v3, v3, v6, v7
    v_cvt_pk_bf16_f32 v176, v2, v3
    v_lshlrev_b32 v2, 16, v177
    v_and_b32 v3, 0xffff0000, v177
    v_fma_f32 v2, v2, v6, v7
    v_fma_f32 v3, v3, v6, v7
    v_cvt_pk_bf16_f32 v177, v2, v3
    v_lshlrev_b32 v2, 16, v178
    v_and_b32 v3, 0xffff0000, v178
    v_fma_f32 v2, v2, v6, v7
    v_fma_f32 v3, v3, v6, v7
    v_cvt_pk_bf16_f32 v178, v2, v3
    v_lshlrev_b32 v2, 16, v179
    v_and_b32 v3, 0xffff0000, v179
    v_fma_f32 v2, v2, v6, v7
    v_fma_f32 v3, v3, v6, v7
    v_cvt_pk_bf16_f32 v179, v2, v3
    v_lshlrev_b32 v2, 16, v180
    v_and_b32 v3, 0xffff0000, v180
    v_fma_f32 v2, v2, v6, v7
    v_fma_f32 v3, v3, v6, v7
    v_cvt_pk_bf16_f32 v180, v2, v3
    v_lshlrev_b32 v2, 16, v181
    v_and_b32 v3, 0xffff0000, v181
    v_fma_f32 v2, v2, v6, v7
    v_fma_f32 v3, v3, v6, v7
    v_cvt_pk_bf16_f32 v181, v2, v3
    v_lshlrev_b32 v2, 16, v182
    v_and_b32 v3, 0xffff0000, v182
    v_fma_f32 v2, v2, v6, v7
    v_fma_f32 v3, v3, v6, v7
    v_cvt_pk_bf16_f32 v182, v2, v3
    v_lshlrev_b32 v2, 16, v183
    v_and_b32 v3, 0xffff0000, v183
    v_fma_f32 v2, v2, v6, v7
    v_fma_f32 v3, v3, v6, v7
    v_cvt_pk_bf16_f32 v183, v2, v3
    v_lshlrev_b32 v2, 16, v184
    v_and_b32 v3, 0xffff0000, v184
    v_fma_f32 v2, v2, v6, v7
    v_fma_f32 v3, v3, v6, v7
    v_cvt_pk_bf16_f32 v184, v2, v3
    v_lshlrev_b32 v2, 16, v185
    v_and_b32 v3, 0xffff0000, v185
    v_fma_f32 v2, v2, v6, v7
    v_fma_f32 v3, v3, v6, v7
    v_cvt_pk_bf16_f32 v185, v2, v3
    v_lshlrev_b32 v2, 16, v186
    v_and_b32 v3, 0xffff0000, v186
    v_fma_f32 v2, v2, v6, v7
    v_fma_f32 v3, v3, v6, v7
    v_cvt_pk_bf16_f32 v186, v2, v3
    v_lshlrev_b32 v2, 16, v187
    v_and_b32 v3, 0xffff0000, v187
    v_fma_f32 v2, v2, v6, v7
    v_fma_f32 v3, v3, v6, v7
    v_cvt_pk_bf16_f32 v187, v2, v3
    v_lshlrev_b32 v2, 16, v188
    v_and_b32 v3, 0xffff0000, v188
    v_fma_f32 v2, v2, v6, v7
    v_fma_f32 v3, v3, v6, v7
    v_cvt_pk_bf16_f32 v188, v2, v3
    v_lshlrev_b32 v2, 16, v189
    v_and_b32 v3, 0xffff0000, v189
    v_fma_f32 v2, v2, v6, v7
    v_fma_f32 v3, v3, v6, v7
    v_cvt_pk_bf16_f32 v189, v2, v3
    v_lshlrev_b32 v2, 16, v190
    v_and_b32 v3, 0xffff0000, v190
    v_fma_f32 v2, v2, v6, v7
    v_fma_f32 v3, v3, v6, v7
    v_cvt_pk_bf16_f32 v190, v2, v3
    v_lshlrev_b32 v2, 16, v191
    v_and_b32 v3, 0xffff0000, v191
    v_fma_f32 v2, v2, v6, v7
    v_fma_f32 v3, v3, v6, v7
    v_cvt_pk_bf16_f32 v191, v2, v3
    v_lshlrev_b32 v2, 16, v192
    v_and_b32 v3, 0xffff0000, v192
    v_fma_f32 v2, v2, v6, v7
    v_fma_f32 v3, v3, v6, v7
    v_cvt_pk_bf16_f32 v192, v2, v3
    v_lshlrev_b32 v2, 16, v193
    v_and_b32 v3, 0xffff0000, v193
    v_fma_f32 v2, v2, v6, v7
    v_fma_f32 v3, v3, v6, v7
    v_cvt_pk_bf16_f32 v193, v2, v3
    v_lshlrev_b32 v2, 16, v194
    v_and_b32 v3, 0xffff0000, v194
    v_fma_f32 v2, v2, v6, v7
    v_fma_f32 v3, v3, v6, v7
    v_cvt_pk_bf16_f32 v194, v2, v3
    v_lshlrev_b32 v2, 16, v195
    v_and_b32 v3, 0xffff0000, v195
    v_fma_f32 v2, v2, v6, v7
    v_fma_f32 v3, v3, v6, v7
    v_cvt_pk_bf16_f32 v195, v2, v3
    v_lshlrev_b32 v2, 16, v196
    v_and_b32 v3, 0xffff0000, v196
    v_fma_f32 v2, v2, v6, v7
    v_fma_f32 v3, v3, v6, v7
    v_cvt_pk_bf16_f32 v196, v2, v3
    v_lshlrev_b32 v2, 16, v197
    v_and_b32 v3, 0xffff0000, v197
    v_fma_f32 v2, v2, v6, v7
    v_fma_f32 v3, v3, v6, v7
    v_cvt_pk_bf16_f32 v197, v2, v3
    v_lshlrev_b32 v2, 16, v198
    v_and_b32 v3, 0xffff0000, v198
    v_fma_f32 v2, v2, v6, v7
    v_fma_f32 v3, v3, v6, v7
    v_cvt_pk_bf16_f32 v198, v2, v3
    v_lshlrev_b32 v2, 16, v199
    v_and_b32 v3, 0xffff0000, v199
    v_fma_f32 v2, v2, v6, v7
    v_fma_f32 v3, v3, v6, v7
    v_cvt_pk_bf16_f32 v199, v2, v3
    v_lshlrev_b32 v2, 16, v200
    v_and_b32 v3, 0xffff0000, v200
    v_fma_f32 v2, v2, v6, v7
    v_fma_f32 v3, v3, v6, v7
    v_cvt_pk_bf16_f32 v200, v2, v3
    v_lshlrev_b32 v2, 16, v201
    v_and_b32 v3, 0xffff0000, v201
    v_fma_f32 v2, v2, v6, v7
    v_fma_f32 v3, v3, v6, v7
    v_cvt_pk_bf16_f32 v201, v2, v3
    v_lshlrev_b32 v2, 16, v202
    v_and_b32 v3, 0xffff0000, v202
    v_fma_f32 v2, v2, v6, v7
    v_fma_f32 v3, v3, v6, v7
    v_cvt_pk_bf16_f32 v202, v2, v3
    v_lshlrev_b32 v2, 16, v203
    v_and_b32 v3, 0xffff0000, v203
    v_fma_f32 v2, v2, v6, v7
    v_fma_f32 v3, v3, v6, v7
    v_cvt_pk_bf16_f32 v203, v2, v3
    v_lshlrev_b32 v2, 16, v204
    v_and_b32 v3, 0xffff0000, v204
    v_fma_f32 v2, v2, v6, v7
    v_fma_f32 v3, v3, v6, v7
    v_cvt_pk_bf16_f32 v204, v2, v3
    v_lshlrev_b32 v2, 16, v205
    v_and_b32 v3, 0xffff0000, v205
    v_fma_f32 v2, v2, v6, v7
    v_fma_f32 v3, v3, v6, v7
    v_cvt_pk_bf16_f32 v205, v2, v3
    v_lshlrev_b32 v2, 16, v206
    v_and_b32 v3, 0xffff0000, v206
    v_fma_f32 v2, v2, v6, v7
    v_fma_f32 v3, v3, v6, v7
    v_cvt_pk_bf16_f32 v206, v2, v3
    v_lshlrev_b32 v2, 16, v207
    v_and_b32 v3, 0xffff0000, v207
    v_fma_f32 v2, v2, v6, v7
    v_fma_f32 v3, v3, v6, v7
    v_cvt_pk_bf16_f32 v207, v2, v3
    v_lshlrev_b32 v2, 16, v208
    v_and_b32 v3, 0xffff0000, v208
    v_fma_f32 v2, v2, v6, v7
    v_fma_f32 v3, v3, v6, v7
    v_cvt_pk_bf16_f32 v208, v2, v3
    v_lshlrev_b32 v2, 16, v209
    v_and_b32 v3, 0xffff0000, v209
    v_fma_f32 v2, v2, v6, v7
    v_fma_f32 v3, v3, v6, v7
    v_cvt_pk_bf16_f32 v209, v2, v3
    v_lshlrev_b32 v2, 16, v210
    v_and_b32 v3, 0xffff0000, v210
    v_fma_f32 v2, v2, v6, v7
    v_fma_f32 v3, v3, v6, v7
    v_cvt_pk_bf16_f32 v210, v2, v3
    v_lshlrev_b32 v2, 16, v211
    v_and_b32 v3, 0xffff0000, v211
    v_fma_f32 v2, v2, v6, v7
    v_fma_f32 v3, v3, v6, v7
    v_cvt_pk_bf16_f32 v211, v2, v3
    v_lshlrev_b32 v2, 16, v212
    v_and_b32 v3, 0xffff0000, v212
    v_fma_f32 v2, v2, v6, v7
    v_fma_f32 v3, v3, v6, v7
    v_cvt_pk_bf16_f32 v212, v2, v3
    v_lshlrev_b32 v2, 16, v213
    v_and_b32 v3, 0xffff0000, v213
    v_fma_f32 v2, v2, v6, v7
    v_fma_f32 v3, v3, v6, v7
    v_cvt_pk_bf16_f32 v213, v2, v3
    v_lshlrev_b32 v2, 16, v214
    v_and_b32 v3, 0xffff0000, v214
    v_fma_f32 v2, v2, v6, v7
    v_fma_f32 v3, v3, v6, v7
    v_cvt_pk_bf16_f32 v214, v2, v3
    v_lshlrev_b32 v2, 16, v215
    v_and_b32 v3, 0xffff0000, v215
    v_fma_f32 v2, v2, v6, v7
    v_fma_f32 v3, v3, v6, v7
    v_cvt_pk_bf16_f32 v215, v2, v3
    v_lshlrev_b32 v2, 16, v216
    v_and_b32 v3, 0xffff0000, v216
    v_fma_f32 v2, v2, v6, v7
    v_fma_f32 v3, v3, v6, v7
    v_cvt_pk_bf16_f32 v216, v2, v3
    v_lshlrev_b32 v2, 16, v217
    v_and_b32 v3, 0xffff0000, v217
    v_fma_f32 v2, v2, v6, v7
    v_fma_f32 v3, v3, v6, v7
    v_cvt_pk_bf16_f32 v217, v2, v3
    v_lshlrev_b32 v2, 16, v218
    v_and_b32 v3, 0xffff0000, v218
    v_fma_f32 v2, v2, v6, v7
    v_fma_f32 v3, v3, v6, v7
    v_cvt_pk_bf16_f32 v218, v2, v3
    v_lshlrev_b32 v2, 16, v219
    v_and_b32 v3, 0xffff0000, v219
    v_fma_f32 v2, v2, v6, v7
    v_fma_f32 v3, v3, v6, v7
    v_cvt_pk_bf16_f32 v219, v2, v3
    v_lshlrev_b32 v2, 16, v220
    v_and_b32 v3, 0xffff0000, v220
    v_fma_f32 v2, v2, v6, v7
    v_fma_f32 v3, v3, v6, v7
    v_cvt_pk_bf16_f32 v220, v2, v3
    v_lshlrev_b32 v2, 16, v221
    v_and_b32 v3, 0xffff0000, v221
    v_fma_f32 v2, v2, v6, v7
    v_fma_f32 v3, v3, v6, v7
    v_cvt_pk_bf16_f32 v221, v2, v3
    v_lshlrev_b32 v2, 16, v222
    v_and_b32 v3, 0xffff0000, v222
    v_fma_f32 v2, v2, v6, v7
    v_fma_f32 v3, v3, v6, v7
    v_cvt_pk_bf16_f32 v222, v2, v3
    v_lshlrev_b32 v2, 16, v223
    v_and_b32 v3, 0xffff0000, v223
    v_fma_f32 v2, v2, v6, v7
    v_fma_f32 v3, v3, v6, v7
    v_cvt_pk_bf16_f32 v223, v2, v3
    v_lshlrev_b32 v2, 16, v224
    v_and_b32 v3, 0xffff0000, v224
    v_fma_f32 v2, v2, v6, v7
    v_fma_f32 v3, v3, v6, v7
    v_cvt_pk_bf16_f32 v224, v2, v3
    v_lshlrev_b32 v2, 16, v225
    v_and_b32 v3, 0xffff0000, v225
    v_fma_f32 v2, v2, v6, v7
    v_fma_f32 v3, v3, v6, v7
    v_cvt_pk_bf16_f32 v225, v2, v3
    v_lshlrev_b32 v2, 16, v226
    v_and_b32 v3, 0xffff0000, v226
    v_fma_f32 v2, v2, v6, v7
    v_fma_f32 v3, v3, v6, v7
    v_cvt_pk_bf16_f32 v226, v2, v3
    v_lshlrev_b32 v2, 16, v227
    v_and_b32 v3, 0xffff0000, v227
    v_fma_f32 v2, v2, v6, v7
    v_fma_f32 v3, v3, v6, v7
    v_cvt_pk_bf16_f32 v227, v2, v3
    v_lshlrev_b32 v2, 16, v228
    v_and_b32 v3, 0xffff0000, v228
    v_fma_f32 v2, v2, v6, v7
    v_fma_f32 v3, v3, v6, v7
    v_cvt_pk_bf16_f32 v228, v2, v3
    v_lshlrev_b32 v2, 16, v229
    v_and_b32 v3, 0xffff0000, v229
    v_fma_f32 v2, v2, v6, v7
    v_fma_f32 v3, v3, v6, v7
    v_cvt_pk_bf16_f32 v229, v2, v3
    v_lshlrev_b32 v2, 16, v230
    v_and_b32 v3, 0xffff0000, v230
    v_fma_f32 v2, v2, v6, v7
    v_fma_f32 v3, v3, v6, v7
    v_cvt_pk_bf16_f32 v230, v2, v3
    v_lshlrev_b32 v2, 16, v231
    v_and_b32 v3, 0xffff0000, v231
    v_fma_f32 v2, v2, v6, v7
    v_fma_f32 v3, v3, v6, v7
    v_cvt_pk_bf16_f32 v231, v2, v3
    v_lshlrev_b32 v2, 16, v232
    v_and_b32 v3, 0xffff0000, v232
    v_fma_f32 v2, v2, v6, v7
    v_fma_f32 v3, v3, v6, v7
    v_cvt_pk_bf16_f32 v232, v2, v3
    v_lshlrev_b32 v2, 16, v233
    v_and_b32 v3, 0xffff0000, v233
    v_fma_f32 v2, v2, v6, v7
    v_fma_f32 v3, v3, v6, v7
    v_cvt_pk_bf16_f32 v233, v2, v3
    v_lshlrev_b32 v2, 16, v234
    v_and_b32 v3, 0xffff0000, v234
    v_fma_f32 v2, v2, v6, v7
    v_fma_f32 v3, v3, v6, v7
    v_cvt_pk_bf16_f32 v234, v2, v3
    v_lshlrev_b32 v2, 16, v235
    v_and_b32 v3, 0xffff0000, v235
    v_fma_f32 v2, v2, v6, v7
    v_fma_f32 v3, v3, v6, v7
    v_cvt_pk_bf16_f32 v235, v2, v3
    v_lshlrev_b32 v2, 16, v236
    v_and_b32 v3, 0xffff0000, v236
    v_fma_f32 v2, v2, v6, v7
    v_fma_f32 v3, v3, v6, v7
    v_cvt_pk_bf16_f32 v236, v2, v3
    v_lshlrev_b32 v2, 16, v237
    v_and_b32 v3, 0xffff0000, v237
    v_fma_f32 v2, v2, v6, v7
    v_fma_f32 v3, v3, v6, v7
    v_cvt_pk_bf16_f32 v237, v2, v3
    v_lshlrev_b32 v2, 16, v238
    v_and_b32 v3, 0xffff0000, v238
    v_fma_f32 v2, v2, v6, v7
    v_fma_f32 v3, v3, v6, v7
    v_cvt_pk_bf16_f32 v238, v2, v3
    v_lshlrev_b32 v2, 16, v239
    v_and_b32 v3, 0xffff0000, v239
    v_fma_f32 v2, v2, v6, v7
    v_fma_f32 v3, v3, v6, v7
    v_cvt_pk_bf16_f32 v239, v2, v3
    v_lshlrev_b32 v2, 16, v240
    v_and_b32 v3, 0xffff0000, v240
    v_fma_f32 v2, v2, v6, v7
    v_fma_f32 v3, v3, v6, v7
    v_cvt_pk_bf16_f32 v240, v2, v3
    v_lshlrev_b32 v2, 16, v241
    v_and_b32 v3, 0xffff0000, v241
    v_fma_f32 v2, v2, v6, v7
    v_fma_f32 v3, v3, v6, v7
    v_cvt_pk_bf16_f32 v241, v2, v3
    v_lshlrev_b32 v2, 16, v242
    v_and_b32 v3, 0xffff0000, v242
    v_fma_f32 v2, v2, v6, v7
    v_fma_f32 v3, v3, v6, v7
    v_cvt_pk_bf16_f32 v242, v2, v3
    v_lshlrev_b32 v2, 16, v243
    v_and_b32 v3, 0xffff0000, v243
    v_fma_f32 v2, v2, v6, v7
    v_fma_f32 v3, v3, v6, v7
    v_cvt_pk_bf16_f32 v243, v2, v3
    v_lshlrev_b32 v2, 16, v244
    v_and_b32 v3, 0xffff0000, v244
    v_fma_f32 v2, v2, v6, v7
    v_fma_f32 v3, v3, v6, v7
    v_cvt_pk_bf16_f32 v244, v2, v3
    v_lshlrev_b32 v2, 16, v245
    v_and_b32 v3, 0xffff0000, v245
    v_fma_f32 v2, v2, v6, v7
    v_fma_f32 v3, v3, v6, v7
    v_cvt_pk_bf16_f32 v245, v2, v3
    v_lshlrev_b32 v2, 16, v246
    v_and_b32 v3, 0xffff0000, v246
    v_fma_f32 v2, v2, v6, v7
    v_fma_f32 v3, v3, v6, v7
    v_cvt_pk_bf16_f32 v246, v2, v3
    v_lshlrev_b32 v2, 16, v247
    v_and_b32 v3, 0xffff0000, v247
    v_fma_f32 v2, v2, v6, v7
    v_fma_f32 v3, v3, v6, v7
    v_cvt_pk_bf16_f32 v247, v2, v3
    v_lshlrev_b32 v2, 16, v248
    v_and_b32 v3, 0xffff0000, v248
    v_fma_f32 v2, v2, v6, v7
    v_fma_f32 v3, v3, v6, v7
    v_cvt_pk_bf16_f32 v248, v2, v3
    v_lshlrev_b32 v2, 16, v249
    v_and_b32 v3, 0xffff0000, v249
    v_fma_f32 v2, v2, v6, v7
    v_fma_f32 v3, v3, v6, v7
    v_cvt_pk_bf16_f32 v249, v2, v3
    v_lshlrev_b32 v2, 16, v250
    v_and_b32 v3, 0xffff0000, v250
    v_fma_f32 v2, v2, v6, v7
    v_fma_f32 v3, v3, v6, v7
    v_cvt_pk_bf16_f32 v250, v2, v3
    v_lshlrev_b32 v2, 16, v251
    v_and_b32 v3, 0xffff0000, v251
    v_fma_f32 v2, v2, v6, v7
    v_fma_f32 v3, v3, v6, v7
    v_cvt_pk_bf16_f32 v251, v2, v3
    v_lshlrev_b32 v2, 16, v252
    v_and_b32 v3, 0xffff0000, v252
    v_fma_f32 v2, v2, v6, v7
    v_fma_f32 v3, v3, v6, v7
    v_cvt_pk_bf16_f32 v252, v2, v3
    v_lshlrev_b32 v2, 16, v253
    v_and_b32 v3, 0xffff0000, v253
    v_fma_f32 v2, v2, v6, v7
    v_fma_f32 v3, v3, v6, v7
    v_cvt_pk_bf16_f32 v253, v2, v3
    v_lshlrev_b32 v2, 16, v254
    v_and_b32 v3, 0xffff0000, v254
    v_fma_f32 v2, v2, v6, v7
    v_fma_f32 v3, v3, v6, v7
    v_cvt_pk_bf16_f32 v254, v2, v3
    v_lshlrev_b32 v2, 16, v255
    v_and_b32 v3, 0xffff0000, v255
    v_fma_f32 v2, v2, v6, v7
    v_fma_f32 v3, v3, v6, v7
    v_cvt_pk_bf16_f32 v255, v2, v3
    v_and_b32 v1, 63, v0
    v_lshrrev_b32 v2, 5, v1
    v_bfe_u32 v3, v1, 2, 2
    v_lshl_add_u32 v2, v2, 3, v3
    v_lshlrev_b32 v2, 6, v2
    v_bfe_u32 v3, v1, 4, 1
    v_lshl_add_u32 v2, v3, 5, v2
    v_and_b32 v3, 3, v1
    v_lshl_add_u32 v13, v3, 3, v2
    s_mov_b32 s34, s5
    s_nop 3
L4_loop:
    s_lshl_b32 s31, s34, 6
    v_lshrrev_b32 v7, 2, v0
    v_and_b32 v8, 3, v0
    v_lshlrev_b32 v9, 4, v0
    s_mov_b32 s7, 2752
    v_mul_lo_u32 v12, v7, s7
    v_lshl_add_u32 v12, v8, 4, v12
    v_add_u32 v12, s31, v12
    s_mov_b32 s7, 0
    buffer_load_dwordx4 v[32:35], v12, s[12:15], s7 offen
    s_mov_b32 s7, 176128
    buffer_load_dwordx4 v[36:39], v12, s[12:15], s7 offen
    s_mov_b32 s7, 352256
    buffer_load_dwordx4 v[40:43], v12, s[12:15], s7 offen
    s_mov_b32 s7, 528384
    buffer_load_dwordx4 v[44:47], v12, s[12:15], s7 offen
    s_mov_b32 s7, 704512
    buffer_load_dwordx4 v[48:51], v12, s[12:15], s7 offen
    s_mov_b32 s7, 880640
    buffer_load_dwordx4 v[52:55], v12, s[12:15], s7 offen
    s_mov_b32 s7, 1056768
    buffer_load_dwordx4 v[56:59], v12, s[12:15], s7 offen
    s_mov_b32 s7, 1232896
    buffer_load_dwordx4 v[60:63], v12, s[12:15], s7 offen
    s_waitcnt vmcnt(7)
    ds_write_b128 v9, v[32:35] offset:0
    s_waitcnt vmcnt(6)
    ds_write_b128 v9, v[36:39] offset:4096
    s_waitcnt vmcnt(5)
    ds_write_b128 v9, v[40:43] offset:8192
    s_waitcnt vmcnt(4)
    ds_write_b128 v9, v[44:47] offset:12288
    s_waitcnt vmcnt(3)
    ds_write_b128 v9, v[48:51] offset:16384
    s_waitcnt vmcnt(2)
    ds_write_b128 v9, v[52:55] offset:20480
    s_waitcnt vmcnt(1)
    ds_write_b128 v9, v[56:59] offset:24576
    s_waitcnt vmcnt(0)
    ds_write_b128 v9, v[60:63] offset:28672
    v_lshrrev_b32 v7, 2, v0
    v_and_b32 v8, 3, v0
    v_lshlrev_b32 v9, 4, v0
    s_mov_b32 s7, 2752
    v_mul_lo_u32 v12, v7, s7
    v_lshl_add_u32 v12, v8, 4, v12
    v_add_u32 v12, s31, v12
    s_mov_b32 s7, 0
    buffer_load_dwordx4 v[32:35], v12, s[16:19], s7 offen
    s_mov_b32 s7, 176128
    buffer_load_dwordx4 v[36:39], v12, s[16:19], s7 offen
    s_mov_b32 s7, 352256
    buffer_load_dwordx4 v[40:43], v12, s[16:19], s7 offen
    s_mov_b32 s7, 528384
    buffer_load_dwordx4 v[44:47], v12, s[16:19], s7 offen
    s_mov_b32 s7, 704512
    buffer_load_dwordx4 v[48:51], v12, s[16:19], s7 offen
    s_mov_b32 s7, 880640
    buffer_load_dwordx4 v[52:55], v12, s[16:19], s7 offen
    s_mov_b32 s7, 1056768
    buffer_load_dwordx4 v[56:59], v12, s[16:19], s7 offen
    s_mov_b32 s7, 1232896
    buffer_load_dwordx4 v[60:63], v12, s[16:19], s7 offen
    s_waitcnt vmcnt(7)
    ds_write_b128 v9, v[32:35] offset:32768
    s_waitcnt vmcnt(6)
    ds_write_b128 v9, v[36:39] offset:36864
    s_waitcnt vmcnt(5)
    ds_write_b128 v9, v[40:43] offset:40960
    s_waitcnt vmcnt(4)
    ds_write_b128 v9, v[44:47] offset:45056
    s_waitcnt vmcnt(3)
    ds_write_b128 v9, v[48:51] offset:49152
    s_waitcnt vmcnt(2)
    ds_write_b128 v9, v[52:55] offset:53248
    s_waitcnt vmcnt(1)
    ds_write_b128 v9, v[56:59] offset:57344
    s_waitcnt vmcnt(0)
    ds_write_b128 v9, v[60:63] offset:61440
    s_waitcnt vmcnt(0) lgkmcnt(0)
    s_barrier
    ds_read_b64_tr_b16 v[32:33], v13 offset:0
    ds_read_b64_tr_b16 v[34:35], v13 offset:256
    ds_read_b64_tr_b16 v[36:37], v13 offset:1024
    ds_read_b64_tr_b16 v[38:39], v13 offset:1280
    ds_read_b64_tr_b16 v[40:41], v13 offset:2048
    ds_read_b64_tr_b16 v[42:43], v13 offset:2304
    ds_read_b64_tr_b16 v[44:45], v13 offset:3072
    ds_read_b64_tr_b16 v[46:47], v13 offset:3328
    s_waitcnt lgkmcnt(6)
    v_mfma_f32_32x32x16_bf16 v[64:79], v[32:35], v[128:131], 0
    ds_read_b64_tr_b16 v[32:33], v13 offset:4096
    ds_read_b64_tr_b16 v[34:35], v13 offset:4352
    s_waitcnt lgkmcnt(6)
    v_mfma_f32_32x32x16_bf16 v[64:79], v[36:39], v[132:135], v[64:79]
    ds_read_b64_tr_b16 v[36:37], v13 offset:5120
    ds_read_b64_tr_b16 v[38:39], v13 offset:5376
    s_waitcnt lgkmcnt(6)
    v_mfma_f32_32x32x16_bf16 v[64:79], v[40:43], v[136:139], v[64:79]
    ds_read_b64_tr_b16 v[40:41], v13 offset:6144
    ds_read_b64_tr_b16 v[42:43], v13 offset:6400
    s_waitcnt lgkmcnt(6)
    v_mfma_f32_32x32x16_bf16 v[64:79], v[44:47], v[140:143], v[64:79]
    ds_read_b64_tr_b16 v[44:45], v13 offset:7168
    ds_read_b64_tr_b16 v[46:47], v13 offset:7424
    s_waitcnt lgkmcnt(6)
    v_mfma_f32_32x32x16_bf16 v[64:79], v[32:35], v[144:147], v[64:79]
    ds_read_b64_tr_b16 v[32:33], v13 offset:8192
    ds_read_b64_tr_b16 v[34:35], v13 offset:8448
    s_waitcnt lgkmcnt(6)
    v_mfma_f32_32x32x16_bf16 v[64:79], v[36:39], v[148:151], v[64:79]
    ds_read_b64_tr_b16 v[36:37], v13 offset:9216
    ds_read_b64_tr_b16 v[38:39], v13 offset:9472
    s_waitcnt lgkmcnt(6)
    v_mfma_f32_32x32x16_bf16 v[64:79], v[40:43], v[152:155], v[64:79]
    ds_read_b64_tr_b16 v[40:41], v13 offset:10240
    ds_read_b64_tr_b16 v[42:43], v13 offset:10496
    s_waitcnt lgkmcnt(6)
    v_mfma_f32_32x32x16_bf16 v[64:79], v[44:47], v[156:159], v[64:79]
    ds_read_b64_tr_b16 v[44:45], v13 offset:11264
    ds_read_b64_tr_b16 v[46:47], v13 offset:11520
    s_waitcnt lgkmcnt(6)
    v_mfma_f32_32x32x16_bf16 v[64:79], v[32:35], v[160:163], v[64:79]
    ds_read_b64_tr_b16 v[32:33], v13 offset:12288
    ds_read_b64_tr_b16 v[34:35], v13 offset:12544
    s_waitcnt lgkmcnt(6)
    v_mfma_f32_32x32x16_bf16 v[64:79], v[36:39], v[164:167], v[64:79]
    ds_read_b64_tr_b16 v[36:37], v13 offset:13312
    ds_read_b64_tr_b16 v[38:39], v13 offset:13568
    s_waitcnt lgkmcnt(6)
    v_mfma_f32_32x32x16_bf16 v[64:79], v[40:43], v[168:171], v[64:79]
    ds_read_b64_tr_b16 v[40:41], v13 offset:14336
    ds_read_b64_tr_b16 v[42:43], v13 offset:14592
    s_waitcnt lgkmcnt(6)
    v_mfma_f32_32x32x16_bf16 v[64:79], v[44:47], v[172:175], v[64:79]
    ds_read_b64_tr_b16 v[44:45], v13 offset:15360
    ds_read_b64_tr_b16 v[46:47], v13 offset:15616
    s_waitcnt lgkmcnt(6)
    v_mfma_f32_32x32x16_bf16 v[64:79], v[32:35], v[176:179], v[64:79]
    ds_read_b64_tr_b16 v[32:33], v13 offset:16384
    ds_read_b64_tr_b16 v[34:35], v13 offset:16640
    s_waitcnt lgkmcnt(6)
    v_mfma_f32_32x32x16_bf16 v[64:79], v[36:39], v[180:183], v[64:79]
    ds_read_b64_tr_b16 v[36:37], v13 offset:17408
    ds_read_b64_tr_b16 v[38:39], v13 offset:17664
    s_waitcnt lgkmcnt(6)
    v_mfma_f32_32x32x16_bf16 v[64:79], v[40:43], v[184:187], v[64:79]
    ds_read_b64_tr_b16 v[40:41], v13 offset:18432
    ds_read_b64_tr_b16 v[42:43], v13 offset:18688
    s_waitcnt lgkmcnt(6)
    v_mfma_f32_32x32x16_bf16 v[64:79], v[44:47], v[188:191], v[64:79]
    ds_read_b64_tr_b16 v[44:45], v13 offset:19456
    ds_read_b64_tr_b16 v[46:47], v13 offset:19712
    s_waitcnt lgkmcnt(6)
    v_mfma_f32_32x32x16_bf16 v[64:79], v[32:35], v[192:195], v[64:79]
    ds_read_b64_tr_b16 v[32:33], v13 offset:20480
    ds_read_b64_tr_b16 v[34:35], v13 offset:20736
    s_waitcnt lgkmcnt(6)
    v_mfma_f32_32x32x16_bf16 v[64:79], v[36:39], v[196:199], v[64:79]
    ds_read_b64_tr_b16 v[36:37], v13 offset:21504
    ds_read_b64_tr_b16 v[38:39], v13 offset:21760
    s_waitcnt lgkmcnt(6)
    v_mfma_f32_32x32x16_bf16 v[64:79], v[40:43], v[200:203], v[64:79]
    ds_read_b64_tr_b16 v[40:41], v13 offset:22528
    ds_read_b64_tr_b16 v[42:43], v13 offset:22784
    s_waitcnt lgkmcnt(6)
    v_mfma_f32_32x32x16_bf16 v[64:79], v[44:47], v[204:207], v[64:79]
    ds_read_b64_tr_b16 v[44:45], v13 offset:23552
    ds_read_b64_tr_b16 v[46:47], v13 offset:23808
    s_waitcnt lgkmcnt(6)
    v_mfma_f32_32x32x16_bf16 v[64:79], v[32:35], v[208:211], v[64:79]
    ds_read_b64_tr_b16 v[32:33], v13 offset:24576
    ds_read_b64_tr_b16 v[34:35], v13 offset:24832
    s_waitcnt lgkmcnt(6)
    v_mfma_f32_32x32x16_bf16 v[64:79], v[36:39], v[212:215], v[64:79]
    ds_read_b64_tr_b16 v[36:37], v13 offset:25600
    ds_read_b64_tr_b16 v[38:39], v13 offset:25856
    s_waitcnt lgkmcnt(6)
    v_mfma_f32_32x32x16_bf16 v[64:79], v[40:43], v[216:219], v[64:79]
    ds_read_b64_tr_b16 v[40:41], v13 offset:26624
    ds_read_b64_tr_b16 v[42:43], v13 offset:26880
    s_waitcnt lgkmcnt(6)
    v_mfma_f32_32x32x16_bf16 v[64:79], v[44:47], v[220:223], v[64:79]
    ds_read_b64_tr_b16 v[44:45], v13 offset:27648
    ds_read_b64_tr_b16 v[46:47], v13 offset:27904
    s_waitcnt lgkmcnt(6)
    v_mfma_f32_32x32x16_bf16 v[64:79], v[32:35], v[224:227], v[64:79]
    ds_read_b64_tr_b16 v[32:33], v13 offset:28672
    ds_read_b64_tr_b16 v[34:35], v13 offset:28928
    s_waitcnt lgkmcnt(6)
    v_mfma_f32_32x32x16_bf16 v[64:79], v[36:39], v[228:231], v[64:79]
    ds_read_b64_tr_b16 v[36:37], v13 offset:29696
    ds_read_b64_tr_b16 v[38:39], v13 offset:29952
    s_waitcnt lgkmcnt(6)
    v_mfma_f32_32x32x16_bf16 v[64:79], v[40:43], v[232:235], v[64:79]
    ds_read_b64_tr_b16 v[40:41], v13 offset:30720
    ds_read_b64_tr_b16 v[42:43], v13 offset:30976
    s_waitcnt lgkmcnt(6)
    v_mfma_f32_32x32x16_bf16 v[64:79], v[44:47], v[236:239], v[64:79]
    ds_read_b64_tr_b16 v[44:45], v13 offset:31744
    ds_read_b64_tr_b16 v[46:47], v13 offset:32000
    s_waitcnt lgkmcnt(6)
    v_mfma_f32_32x32x16_bf16 v[64:79], v[32:35], v[240:243], v[64:79]
    s_waitcnt lgkmcnt(4)
    v_mfma_f32_32x32x16_bf16 v[64:79], v[36:39], v[244:247], v[64:79]
    s_waitcnt lgkmcnt(2)
    v_mfma_f32_32x32x16_bf16 v[64:79], v[40:43], v[248:251], v[64:79]
    s_waitcnt lgkmcnt(0)
    v_mfma_f32_32x32x16_bf16 v[64:79], v[44:47], v[252:255], v[64:79]
    ds_read_b64_tr_b16 v[48:49], v13 offset:32768
    ds_read_b64_tr_b16 v[50:51], v13 offset:33024
    ds_read_b64_tr_b16 v[52:53], v13 offset:33792
    ds_read_b64_tr_b16 v[54:55], v13 offset:34048
    ds_read_b64_tr_b16 v[56:57], v13 offset:34816
    ds_read_b64_tr_b16 v[58:59], v13 offset:35072
    ds_read_b64_tr_b16 v[60:61], v13 offset:35840
    ds_read_b64_tr_b16 v[62:63], v13 offset:36096
    s_waitcnt lgkmcnt(6)
    v_mfma_f32_32x32x16_bf16 v[80:95], v[48:51], v[128:131], 0
    ds_read_b64_tr_b16 v[48:49], v13 offset:36864
    ds_read_b64_tr_b16 v[50:51], v13 offset:37120
    s_waitcnt lgkmcnt(6)
    v_mfma_f32_32x32x16_bf16 v[80:95], v[52:55], v[132:135], v[80:95]
    ds_read_b64_tr_b16 v[52:53], v13 offset:37888
    ds_read_b64_tr_b16 v[54:55], v13 offset:38144
    s_waitcnt lgkmcnt(6)
    v_mfma_f32_32x32x16_bf16 v[80:95], v[56:59], v[136:139], v[80:95]
    ds_read_b64_tr_b16 v[56:57], v13 offset:38912
    ds_read_b64_tr_b16 v[58:59], v13 offset:39168
    s_waitcnt lgkmcnt(6)
    v_mfma_f32_32x32x16_bf16 v[80:95], v[60:63], v[140:143], v[80:95]
    ds_read_b64_tr_b16 v[60:61], v13 offset:39936
    ds_read_b64_tr_b16 v[62:63], v13 offset:40192
    s_waitcnt lgkmcnt(6)
    v_mfma_f32_32x32x16_bf16 v[80:95], v[48:51], v[144:147], v[80:95]
    ds_read_b64_tr_b16 v[48:49], v13 offset:40960
    ds_read_b64_tr_b16 v[50:51], v13 offset:41216
    s_waitcnt lgkmcnt(6)
    v_mfma_f32_32x32x16_bf16 v[80:95], v[52:55], v[148:151], v[80:95]
    ds_read_b64_tr_b16 v[52:53], v13 offset:41984
    ds_read_b64_tr_b16 v[54:55], v13 offset:42240
    s_waitcnt lgkmcnt(6)
    v_mfma_f32_32x32x16_bf16 v[80:95], v[56:59], v[152:155], v[80:95]
    ds_read_b64_tr_b16 v[56:57], v13 offset:43008
    ds_read_b64_tr_b16 v[58:59], v13 offset:43264
    s_waitcnt lgkmcnt(6)
    v_mfma_f32_32x32x16_bf16 v[80:95], v[60:63], v[156:159], v[80:95]
    ds_read_b64_tr_b16 v[60:61], v13 offset:44032
    ds_read_b64_tr_b16 v[62:63], v13 offset:44288
    s_waitcnt lgkmcnt(6)
    v_mfma_f32_32x32x16_bf16 v[80:95], v[48:51], v[160:163], v[80:95]
    ds_read_b64_tr_b16 v[48:49], v13 offset:45056
    ds_read_b64_tr_b16 v[50:51], v13 offset:45312
    s_waitcnt lgkmcnt(6)
    v_mfma_f32_32x32x16_bf16 v[80:95], v[52:55], v[164:167], v[80:95]
    ds_read_b64_tr_b16 v[52:53], v13 offset:46080
    ds_read_b64_tr_b16 v[54:55], v13 offset:46336
    s_waitcnt lgkmcnt(6)
    v_mfma_f32_32x32x16_bf16 v[80:95], v[56:59], v[168:171], v[80:95]
    ds_read_b64_tr_b16 v[56:57], v13 offset:47104
    ds_read_b64_tr_b16 v[58:59], v13 offset:47360
    s_waitcnt lgkmcnt(6)
    v_mfma_f32_32x32x16_bf16 v[80:95], v[60:63], v[172:175], v[80:95]
    ds_read_b64_tr_b16 v[60:61], v13 offset:48128
    ds_read_b64_tr_b16 v[62:63], v13 offset:48384
    s_waitcnt lgkmcnt(6)
    v_mfma_f32_32x32x16_bf16 v[80:95], v[48:51], v[176:179], v[80:95]
    ds_read_b64_tr_b16 v[48:49], v13 offset:49152
    ds_read_b64_tr_b16 v[50:51], v13 offset:49408
    s_waitcnt lgkmcnt(6)
    v_mfma_f32_32x32x16_bf16 v[80:95], v[52:55], v[180:183], v[80:95]
    ds_read_b64_tr_b16 v[52:53], v13 offset:50176
    ds_read_b64_tr_b16 v[54:55], v13 offset:50432
    s_waitcnt lgkmcnt(6)
    v_mfma_f32_32x32x16_bf16 v[80:95], v[56:59], v[184:187], v[80:95]
    ds_read_b64_tr_b16 v[56:57], v13 offset:51200
    ds_read_b64_tr_b16 v[58:59], v13 offset:51456
    s_waitcnt lgkmcnt(6)
    v_mfma_f32_32x32x16_bf16 v[80:95], v[60:63], v[188:191], v[80:95]
    ds_read_b64_tr_b16 v[60:61], v13 offset:52224
    ds_read_b64_tr_b16 v[62:63], v13 offset:52480
    s_waitcnt lgkmcnt(6)
    v_mfma_f32_32x32x16_bf16 v[80:95], v[48:51], v[192:195], v[80:95]
    ds_read_b64_tr_b16 v[48:49], v13 offset:53248
    ds_read_b64_tr_b16 v[50:51], v13 offset:53504
    s_waitcnt lgkmcnt(6)
    v_mfma_f32_32x32x16_bf16 v[80:95], v[52:55], v[196:199], v[80:95]
    ds_read_b64_tr_b16 v[52:53], v13 offset:54272
    ds_read_b64_tr_b16 v[54:55], v13 offset:54528
    s_waitcnt lgkmcnt(6)
    v_mfma_f32_32x32x16_bf16 v[80:95], v[56:59], v[200:203], v[80:95]
    ds_read_b64_tr_b16 v[56:57], v13 offset:55296
    ds_read_b64_tr_b16 v[58:59], v13 offset:55552
    s_waitcnt lgkmcnt(6)
    v_mfma_f32_32x32x16_bf16 v[80:95], v[60:63], v[204:207], v[80:95]
    ds_read_b64_tr_b16 v[60:61], v13 offset:56320
    ds_read_b64_tr_b16 v[62:63], v13 offset:56576
    s_waitcnt lgkmcnt(6)
    v_mfma_f32_32x32x16_bf16 v[80:95], v[48:51], v[208:211], v[80:95]
    ds_read_b64_tr_b16 v[48:49], v13 offset:57344
    ds_read_b64_tr_b16 v[50:51], v13 offset:57600
    s_waitcnt lgkmcnt(6)
    v_mfma_f32_32x32x16_bf16 v[80:95], v[52:55], v[212:215], v[80:95]
    ds_read_b64_tr_b16 v[52:53], v13 offset:58368
    ds_read_b64_tr_b16 v[54:55], v13 offset:58624
    s_waitcnt lgkmcnt(6)
    v_mfma_f32_32x32x16_bf16 v[80:95], v[56:59], v[216:219], v[80:95]
    ds_read_b64_tr_b16 v[56:57], v13 offset:59392
    ds_read_b64_tr_b16 v[58:59], v13 offset:59648
    s_waitcnt lgkmcnt(6)
    v_mfma_f32_32x32x16_bf16 v[80:95], v[60:63], v[220:223], v[80:95]
    ds_read_b64_tr_b16 v[60:61], v13 offset:60416
    ds_read_b64_tr_b16 v[62:63], v13 offset:60672
    s_waitcnt lgkmcnt(6)
    v_mfma_f32_32x32x16_bf16 v[80:95], v[48:51], v[224:227], v[80:95]
    ds_read_b64_tr_b16 v[48:49], v13 offset:61440
    ds_read_b64_tr_b16 v[50:51], v13 offset:61696
    s_waitcnt lgkmcnt(6)
    v_mfma_f32_32x32x16_bf16 v[80:95], v[52:55], v[228:231], v[80:95]
    ds_read_b64_tr_b16 v[52:53], v13 offset:62464
    ds_read_b64_tr_b16 v[54:55], v13 offset:62720
    s_waitcnt lgkmcnt(6)
    v_mfma_f32_32x32x16_bf16 v[80:95], v[56:59], v[232:235], v[80:95]
    ds_read_b64_tr_b16 v[56:57], v13 offset:63488
    ds_read_b64_tr_b16 v[58:59], v13 offset:63744
    s_waitcnt lgkmcnt(6)
    v_mfma_f32_32x32x16_bf16 v[80:95], v[60:63], v[236:239], v[80:95]
    ds_read_b64_tr_b16 v[60:61], v13 offset:64512
    ds_read_b64_tr_b16 v[62:63], v13 offset:64768
    s_waitcnt lgkmcnt(6)
    v_mfma_f32_32x32x16_bf16 v[80:95], v[48:51], v[240:243], v[80:95]
    s_waitcnt lgkmcnt(4)
    v_mfma_f32_32x32x16_bf16 v[80:95], v[52:55], v[244:247], v[80:95]
    s_waitcnt lgkmcnt(2)
    v_mfma_f32_32x32x16_bf16 v[80:95], v[56:59], v[248:251], v[80:95]
    s_waitcnt lgkmcnt(0)
    v_mfma_f32_32x32x16_bf16 v[80:95], v[60:63], v[252:255], v[80:95]
    s_barrier
    s_mov_b32 s7, 2752
    v_mul_lo_u32 v6, v10, s7
    v_lshl_add_u32 v6, v11, 3, v6
    v_add_u32 v6, s31, v6
    s_mov_b32 s30, 0xbfb8aa3b
    v_add_u32 v6, 0x700000, v6
    v_mul_f32 v2, s30, v64
    v_exp_f32 v2, v2
    s_nop 0
    v_add_f32 v2, 1.0, v2
    v_rcp_f32 v2, v2
    s_nop 0
    v_mul_f32 v64, v64, v2
    v_mul_f32 v64, v64, v80
    v_mul_f32 v2, s30, v65
    v_exp_f32 v2, v2
    s_nop 0
    v_add_f32 v2, 1.0, v2
    v_rcp_f32 v2, v2
    s_nop 0
    v_mul_f32 v65, v65, v2
    v_mul_f32 v65, v65, v81
    v_mul_f32 v2, s30, v66
    v_exp_f32 v2, v2
    s_nop 0
    v_add_f32 v2, 1.0, v2
    v_rcp_f32 v2, v2
    s_nop 0
    v_mul_f32 v66, v66, v2
    v_mul_f32 v66, v66, v82
    v_mul_f32 v2, s30, v67
    v_exp_f32 v2, v2
    s_nop 0
    v_add_f32 v2, 1.0, v2
    v_rcp_f32 v2, v2
    s_nop 0
    v_mul_f32 v67, v67, v2
    v_mul_f32 v67, v67, v83
    v_cvt_pk_bf16_f32 v2, v64, v65
    v_cvt_pk_bf16_f32 v3, v66, v67
    buffer_store_dwordx2 v[2:3], v6, s[20:23], 0 offen offset:0
    s_nop 1
    v_mul_f32 v2, s30, v68
    v_exp_f32 v2, v2
    s_nop 0
    v_add_f32 v2, 1.0, v2
    v_rcp_f32 v2, v2
    s_nop 0
    v_mul_f32 v68, v68, v2
    v_mul_f32 v68, v68, v84
    v_mul_f32 v2, s30, v69
    v_exp_f32 v2, v2
    s_nop 0
    v_add_f32 v2, 1.0, v2
    v_rcp_f32 v2, v2
    s_nop 0
    v_mul_f32 v69, v69, v2
    v_mul_f32 v69, v69, v85
    v_mul_f32 v2, s30, v70
    v_exp_f32 v2, v2
    s_nop 0
    v_add_f32 v2, 1.0, v2
    v_rcp_f32 v2, v2
    s_nop 0
    v_mul_f32 v70, v70, v2
    v_mul_f32 v70, v70, v86
    v_mul_f32 v2, s30, v71
    v_exp_f32 v2, v2
    s_nop 0
    v_add_f32 v2, 1.0, v2
    v_rcp_f32 v2, v2
    s_nop 0
    v_mul_f32 v71, v71, v2
    v_mul_f32 v71, v71, v87
    v_cvt_pk_bf16_f32 v2, v68, v69
    v_cvt_pk_bf16_f32 v3, v70, v71
    buffer_store_dwordx2 v[2:3], v6, s[20:23], 0 offen offset:16
    s_nop 1
    v_mul_f32 v2, s30, v72
    v_exp_f32 v2, v2
    s_nop 0
    v_add_f32 v2, 1.0, v2
    v_rcp_f32 v2, v2
    s_nop 0
    v_mul_f32 v72, v72, v2
    v_mul_f32 v72, v72, v88
    v_mul_f32 v2, s30, v73
    v_exp_f32 v2, v2
    s_nop 0
    v_add_f32 v2, 1.0, v2
    v_rcp_f32 v2, v2
    s_nop 0
    v_mul_f32 v73, v73, v2
    v_mul_f32 v73, v73, v89
    v_mul_f32 v2, s30, v74
    v_exp_f32 v2, v2
    s_nop 0
    v_add_f32 v2, 1.0, v2
    v_rcp_f32 v2, v2
    s_nop 0
    v_mul_f32 v74, v74, v2
    v_mul_f32 v74, v74, v90
    v_mul_f32 v2, s30, v75
    v_exp_f32 v2, v2
    s_nop 0
    v_add_f32 v2, 1.0, v2
    v_rcp_f32 v2, v2
    s_nop 0
    v_mul_f32 v75, v75, v2
    v_mul_f32 v75, v75, v91
    v_cvt_pk_bf16_f32 v2, v72, v73
    v_cvt_pk_bf16_f32 v3, v74, v75
    buffer_store_dwordx2 v[2:3], v6, s[20:23], 0 offen offset:32
    s_nop 1
    v_mul_f32 v2, s30, v76
    v_exp_f32 v2, v2
    s_nop 0
    v_add_f32 v2, 1.0, v2
    v_rcp_f32 v2, v2
    s_nop 0
    v_mul_f32 v76, v76, v2
    v_mul_f32 v76, v76, v92
    v_mul_f32 v2, s30, v77
    v_exp_f32 v2, v2
    s_nop 0
    v_add_f32 v2, 1.0, v2
    v_rcp_f32 v2, v2
    s_nop 0
    v_mul_f32 v77, v77, v2
    v_mul_f32 v77, v77, v93
    v_mul_f32 v2, s30, v78
    v_exp_f32 v2, v2
    s_nop 0
    v_add_f32 v2, 1.0, v2
    v_rcp_f32 v2, v2
    s_nop 0
    v_mul_f32 v78, v78, v2
    v_mul_f32 v78, v78, v94
    v_mul_f32 v2, s30, v79
    v_exp_f32 v2, v2
    s_nop 0
    v_add_f32 v2, 1.0, v2
    v_rcp_f32 v2, v2
    s_nop 0
    v_mul_f32 v79, v79, v2
    v_mul_f32 v79, v79, v95
    v_cvt_pk_bf16_f32 v2, v76, v77
    v_cvt_pk_bf16_f32 v3, v78, v79
    buffer_store_dwordx2 v[2:3], v6, s[20:23], 0 offen offset:48
    s_nop 1
    s_add_u32 s34, s34, 16
    s_cmp_lt_u32 s34, 43
    s_nop 3
    s_cbranch_scc1 L4_loop
    s_nop 3
L4_end:
    s_endpgm
.globl k5_kernel
.p2align 8
.type k5_kernel,@function
k5_kernel:
    s_cmp_ge_u32 s2, 256
    s_cbranch_scc1 L5_end
    s_load_dwordx2 s[12:13], s[0:1], 64
    s_load_dwordx2 s[16:17], s[0:1], 72
    s_load_dwordx2 s[20:21], s[0:1], 88
    s_and_b32 s4, s2, 15
    s_lshr_b32 s5, s2, 4
    v_lshrrev_b32 v2, 6, v0
    v_and_b32 v3, 31, v0
    v_bfe_u32 v11, v0, 5, 1
    s_lshl_b32 s6, s4, 7
    v_lshlrev_b32 v10, 5, v2
    v_add_u32 v10, v10, v3
    v_add_u32 v10, s6, v10
    s_mov_b32 s7, 2752
    v_mul_lo_u32 v14, v10, s7
    v_lshl_add_u32 v14, v11, 4, v14
    s_waitcnt lgkmcnt(0)
    s_mov_b32 s14, 1409024
    s_mov_b32 s15, 0x00020000
    s_mov_b32 s18, 2097152
    s_mov_b32 s19, 0x00020000
    s_mov_b32 s22, 16777216
    s_mov_b32 s23, 0x00020000
    v_add_u32 v14, 0x700000, v14
    s_lshl_b32 s31, s5, 6
    v_lshrrev_b32 v7, 2, v0
    v_and_b32 v8, 3, v0
    v_lshlrev_b32 v9, 4, v0
    v_lshlrev_b32 v12, 10, v7
    v_lshl_add_u32 v12, v8, 4, v12
    v_add_u32 v12, s31, v12
    s_mov_b32 s7, 0
    buffer_load_dwordx4 v[32:35], v12, s[12:15], s7 offen
    s_mov_b32 s7, 65536
    buffer_load_dwordx4 v[36:39], v12, s[12:15], s7 offen
    s_mov_b32 s7, 131072
    buffer_load_dwordx4 v[40:43], v12, s[12:15], s7 offen
    s_mov_b32 s7, 196608
    buffer_load_dwordx4 v[44:47], v12, s[12:15], s7 offen
    s_mov_b32 s7, 262144
    buffer_load_dwordx4 v[48:51], v12, s[12:15], s7 offen
    s_mov_b32 s7, 327680
    buffer_load_dwordx4 v[52:55], v12, s[12:15], s7 offen
    s_mov_b32 s7, 393216
    buffer_load_dwordx4 v[56:59], v12, s[12:15], s7 offen
    s_mov_b32 s7, 458752
    buffer_load_dwordx4 v[60:63], v12, s[12:15], s7 offen
    s_waitcnt vmcnt(7)
    ds_write_b128 v9, v[32:35] offset:0
    s_waitcnt vmcnt(6)
    ds_write_b128 v9, v[36:39] offset:4096
    s_waitcnt vmcnt(5)
    ds_write_b128 v9, v[40:43] offset:8192
    s_waitcnt vmcnt(4)
    ds_write_b128 v9, v[44:47] offset:12288
    s_waitcnt vmcnt(3)
    ds_write_b128 v9, v[48:51] offset:16384
    s_waitcnt vmcnt(2)
    ds_write_b128 v9, v[52:55] offset:20480
    s_waitcnt vmcnt(1)
    ds_write_b128 v9, v[56:59] offset:24576
    s_waitcnt vmcnt(0)
    ds_write_b128 v9, v[60:63] offset:28672
    s_mov_b32 s7, 524288
    buffer_load_dwordx4 v[32:35], v12, s[12:15], s7 offen
    s_mov_b32 s7, 589824
    buffer_load_dwordx4 v[36:39], v12, s[12:15], s7 offen
    s_mov_b32 s7, 655360
    buffer_load_dwordx4 v[40:43], v12, s[12:15], s7 offen
    s_mov_b32 s7, 720896
    buffer_load_dwordx4 v[44:47], v12, s[12:15], s7 offen
    s_mov_b32 s7, 786432
    buffer_load_dwordx4 v[48:51], v12, s[12:15], s7 offen
    s_mov_b32 s7, 851968
    buffer_load_dwordx4 v[52:55], v12, s[12:15], s7 offen
    s_mov_b32 s7, 917504
    buffer_load_dwordx4 v[56:59], v12, s[12:15], s7 offen
    s_mov_b32 s7, 983040
    buffer_load_dwordx4 v[60:63], v12, s[12:15], s7 offen
    s_waitcnt vmcnt(7)
    ds_write_b128 v9, v[32:35] offset:32768
    s_waitcnt vmcnt(6)
    ds_write_b128 v9, v[36:39] offset:36864
    s_waitcnt vmcnt(5)
    ds_write_b128 v9, v[40:43] offset:40960
    s_waitcnt vmcnt(4)
    ds_write_b128 v9, v[44:47] offset:45056
    s_waitcnt vmcnt(3)
    ds_write_b128 v9, v[48:51] offset:49152
    s_waitcnt vmcnt(2)
    ds_write_b128 v9, v[52:55] offset:53248
    s_waitcnt vmcnt(1)
    ds_write_b128 v9, v[56:59] offset:57344
    s_waitcnt vmcnt(0)
    ds_write_b128 v9, v[60:63] offset:61440
    s_mov_b32 s7, 1048576
    buffer_load_dwordx4 v[32:35], v12, s[12:15], s7 offen
    s_mov_b32 s7, 1114112
    buffer_load_dwordx4 v[36:39], v12, s[12:15], s7 offen
    s_mov_b32 s7, 1179648
    buffer_load_dwordx4 v[40:43], v12, s[12:15], s7 offen
    s_mov_b32 s7, 1245184
    buffer_load_dwordx4 v[44:47], v12, s[12:15], s7 offen
    s_mov_b32 s7, 1310720
    buffer_load_dwordx4 v[48:51], v12, s[12:15], s7 offen
    s_mov_b32 s7, 1376256
    buffer_load_dwordx4 v[52:55], v12, s[12:15], s7 offen
    s_waitcnt vmcnt(5)
    v_add_u32 v15, 0x10000, v9
    ds_write_b128 v15, v[32:35] offset:0
    s_waitcnt vmcnt(4)
    v_add_u32 v15, 0x10000, v9
    ds_write_b128 v15, v[36:39] offset:4096
    s_waitcnt vmcnt(3)
    v_add_u32 v15, 0x10000, v9
    ds_write_b128 v15, v[40:43] offset:8192
    s_waitcnt vmcnt(2)
    v_add_u32 v15, 0x10000, v9
    ds_write_b128 v15, v[44:47] offset:12288
    s_waitcnt vmcnt(1)
    v_add_u32 v15, 0x10000, v9
    ds_write_b128 v15, v[48:51] offset:16384
    s_waitcnt vmcnt(0)
    v_cmp_gt_u32 vcc, 128, v0
    s_nop 3
    s_and_saveexec_b64 s[28:29], vcc
    v_add_u32 v15, 0x10000, v9
    ds_write_b128 v15, v[52:55] offset:20480
    s_mov_b64 exec, s[28:29]
    v_and_b32 v1, 63, v0
    v_lshrrev_b32 v2, 5, v1
    v_bfe_u32 v3, v1, 2, 2
    v_lshl_add_u32 v2, v2, 3, v3
    v_lshlrev_b32 v2, 6, v2
    v_bfe_u32 v3, v1, 4, 1
    v_lshl_add_u32 v2, v3, 5, v2
    v_and_b32 v3, 3, v1
    v_lshl_add_u32 v12, v3, 3, v2
    v_add_u32 v13, 0x10000, v12
    s_waitcnt vmcnt(0) lgkmcnt(0)
    s_barrier
    buffer_load_dwordx4 v[128:131], v14, s[20:23], 0 offen offset:0
    buffer_load_dwordx4 v[132:135], v14, s[20:23], 0 offen offset:32
    buffer_load_dwordx4 v[136:139], v14, s[20:23], 0 offen offset:64
    buffer_load_dwordx4 v[140:143], v14, s[20:23], 0 offen offset:96
    buffer_load_dwordx4 v[144:147], v14, s[20:23], 0 offen offset:128
    buffer_load_dwordx4 v[148:151], v14, s[20:23], 0 offen offset:160
    buffer_load_dwordx4 v[152:155], v14, s[20:23], 0 offen offset:192
    buffer_load_dwordx4 v[156:159], v14, s[20:23], 0 offen offset:224
    buffer_load_dwordx4 v[160:163], v14, s[20:23], 0 offen offset:256
    buffer_load_dwordx4 v[164:167], v14, s[20:23], 0 offen offset:288
    buffer_load_dwordx4 v[168:171], v14, s[20:23], 0 offen offset:320
    buffer_load_dwordx4 v[172:175], v14, s[20:23], 0 offen offset:352
    buffer_load_dwordx4 v[176:179], v14, s[20:23], 0 offen offset:384
    buffer_load_dwordx4 v[180:183], v14, s[20:23], 0 offen offset:416
    buffer_load_dwordx4 v[184:187], v14, s[20:23], 0 offen offset:448
    buffer_load_dwordx4 v[188:191], v14, s[20:23], 0 offen offset:480
    buffer_load_dwordx4 v[192:195], v14, s[20:23], 0 offen offset:512
    buffer_load_dwordx4 v[196:199], v14, s[20:23], 0 offen offset:544
    buffer_load_dwordx4 v[200:203], v14, s[20:23], 0 offen offset:576
    buffer_load_dwordx4 v[204:207], v14, s[20:23], 0 offen offset:608
    buffer_load_dwordx4 v[208:211], v14, s[20:23], 0 offen offset:640
    buffer_load_dwordx4 v[212:215], v14, s[20:23], 0 offen offset:672
    buffer_load_dwordx4 v[216:219], v14, s[20:23], 0 offen offset:704
    buffer_load_dwordx4 v[220:223], v14, s[20:23], 0 offen offset:736
    buffer_load_dwordx4 v[224:227], v14, s[20:23], 0 offen offset:768
    buffer_load_dwordx4 v[228:231], v14, s[20:23], 0 offen offset:800
    buffer_load_dwordx4 v[232:235], v14, s[20:23], 0 offen offset:832
    buffer_load_dwordx4 v[236:239], v14, s[20:23], 0 offen offset:864
    buffer_load_dwordx4 v[240:243], v14, s[20:23], 0 offen offset:896
    buffer_load_dwordx4 v[244:247], v14, s[20:23], 0 offen offset:928
    buffer_load_dwordx4 v[248:251], v14, s[20:23], 0 offen offset:960
    buffer_load_dwordx4 v[252:255], v14, s[20:23], 0 offen offset:992
    s_waitcnt vmcnt(0)
    ds_read_b64_tr_b16 v[32:33], v12 offset:0
    ds_read_b64_tr_b16 v[34:35], v12 offset:256
    ds_read_b64_tr_b16 v[36:37], v12 offset:1024
    ds_read_b64_tr_b16 v[38:39], v12 offset:1280
    ds_read_b64_tr_b16 v[40:41], v12 offset:2048
    ds_read_b64_tr_b16 v[42:43], v12 offset:2304
    ds_read_b64_tr_b16 v[44:45], v12 offset:3072
    ds_read_b64_tr_b16 v[46:47], v12 offset:3328
    s_waitcnt lgkmcnt(6)
    v_mfma_f32_32x32x16_bf16 v[16:31], v[32:35], v[128:131], 0
    ds_read_b64_tr_b16 v[32:33], v12 offset:4096
    ds_read_b64_tr_b16 v[34:35], v12 offset:4352
    s_waitcnt lgkmcnt(6)
    v_mfma_f32_32x32x16_bf16 v[16:31], v[36:39], v[132:135], v[16:31]
    ds_read_b64_tr_b16 v[36:37], v12 offset:5120
    ds_read_b64_tr_b16 v[38:39], v12 offset:5376
    s_waitcnt lgkmcnt(6)
    v_mfma_f32_32x32x16_bf16 v[16:31], v[40:43], v[136:139], v[16:31]
    ds_read_b64_tr_b16 v[40:41], v12 offset:6144
    ds_read_b64_tr_b16 v[42:43], v12 offset:6400
    s_waitcnt lgkmcnt(6)
    v_mfma_f32_32x32x16_bf16 v[16:31], v[44:47], v[140:143], v[16:31]
    ds_read_b64_tr_b16 v[44:45], v12 offset:7168
    ds_read_b64_tr_b16 v[46:47], v12 offset:7424
    s_waitcnt lgkmcnt(6)
    v_mfma_f32_32x32x16_bf16 v[16:31], v[32:35], v[144:147], v[16:31]
    ds_read_b64_tr_b16 v[32:33], v12 offset:8192
    ds_read_b64_tr_b16 v[34:35], v12 offset:8448
    s_waitcnt lgkmcnt(6)
    v_mfma_f32_32x32x16_bf16 v[16:31], v[36:39], v[148:151], v[16:31]
    ds_read_b64_tr_b16 v[36:37], v12 offset:9216
    ds_read_b64_tr_b16 v[38:39], v12 offset:9472
    s_waitcnt lgkmcnt(6)
    v_mfma_f32_32x32x16_bf16 v[16:31], v[40:43], v[152:155], v[16:31]
    ds_read_b64_tr_b16 v[40:41], v12 offset:10240
    ds_read_b64_tr_b16 v[42:43], v12 offset:10496
    s_waitcnt lgkmcnt(6)
    v_mfma_f32_32x32x16_bf16 v[16:31], v[44:47], v[156:159], v[16:31]
    ds_read_b64_tr_b16 v[44:45], v12 offset:11264
    ds_read_b64_tr_b16 v[46:47], v12 offset:11520
    s_waitcnt lgkmcnt(6)
    v_mfma_f32_32x32x16_bf16 v[16:31], v[32:35], v[160:163], v[16:31]
    ds_read_b64_tr_b16 v[32:33], v12 offset:12288
    ds_read_b64_tr_b16 v[34:35], v12 offset:12544
    s_waitcnt lgkmcnt(6)
    v_mfma_f32_32x32x16_bf16 v[16:31], v[36:39], v[164:167], v[16:31]
    ds_read_b64_tr_b16 v[36:37], v12 offset:13312
    ds_read_b64_tr_b16 v[38:39], v12 offset:13568
    s_waitcnt lgkmcnt(6)
    v_mfma_f32_32x32x16_bf16 v[16:31], v[40:43], v[168:171], v[16:31]
    ds_read_b64_tr_b16 v[40:41], v12 offset:14336
    ds_read_b64_tr_b16 v[42:43], v12 offset:14592
    s_waitcnt lgkmcnt(6)
    v_mfma_f32_32x32x16_bf16 v[16:31], v[44:47], v[172:175], v[16:31]
    ds_read_b64_tr_b16 v[44:45], v12 offset:15360
    ds_read_b64_tr_b16 v[46:47], v12 offset:15616
    s_waitcnt lgkmcnt(6)
    v_mfma_f32_32x32x16_bf16 v[16:31], v[32:35], v[176:179], v[16:31]
    ds_read_b64_tr_b16 v[32:33], v12 offset:16384
    ds_read_b64_tr_b16 v[34:35], v12 offset:16640
    s_waitcnt lgkmcnt(6)
    v_mfma_f32_32x32x16_bf16 v[16:31], v[36:39], v[180:183], v[16:31]
    ds_read_b64_tr_b16 v[36:37], v12 offset:17408
    ds_read_b64_tr_b16 v[38:39], v12 offset:17664
    s_waitcnt lgkmcnt(6)
    v_mfma_f32_32x32x16_bf16 v[16:31], v[40:43], v[184:187], v[16:31]
    ds_read_b64_tr_b16 v[40:41], v12 offset:18432
    ds_read_b64_tr_b16 v[42:43], v12 offset:18688
    s_waitcnt lgkmcnt(6)
    v_mfma_f32_32x32x16_bf16 v[16:31], v[44:47], v[188:191], v[16:31]
    ds_read_b64_tr_b16 v[44:45], v12 offset:19456
    ds_read_b64_tr_b16 v[46:47], v12 offset:19712
    s_waitcnt lgkmcnt(6)
    v_mfma_f32_32x32x16_bf16 v[16:31], v[32:35], v[192:195], v[16:31]
    ds_read_b64_tr_b16 v[32:33], v12 offset:20480
    ds_read_b64_tr_b16 v[34:35], v12 offset:20736
    s_waitcnt lgkmcnt(6)
    v_mfma_f32_32x32x16_bf16 v[16:31], v[36:39], v[196:199], v[16:31]
    ds_read_b64_tr_b16 v[36:37], v12 offset:21504
    ds_read_b64_tr_b16 v[38:39], v12 offset:21760
    s_waitcnt lgkmcnt(6)
    v_mfma_f32_32x32x16_bf16 v[16:31], v[40:43], v[200:203], v[16:31]
    ds_read_b64_tr_b16 v[40:41], v12 offset:22528
    ds_read_b64_tr_b16 v[42:43], v12 offset:22784
    s_waitcnt lgkmcnt(6)
    v_mfma_f32_32x32x16_bf16 v[16:31], v[44:47], v[204:207], v[16:31]
    ds_read_b64_tr_b16 v[44:45], v12 offset:23552
    ds_read_b64_tr_b16 v[46:47], v12 offset:23808
    s_waitcnt lgkmcnt(6)
    v_mfma_f32_32x32x16_bf16 v[16:31], v[32:35], v[208:211], v[16:31]
    ds_read_b64_tr_b16 v[32:33], v12 offset:24576
    ds_read_b64_tr_b16 v[34:35], v12 offset:24832
    s_waitcnt lgkmcnt(6)
    v_mfma_f32_32x32x16_bf16 v[16:31], v[36:39], v[212:215], v[16:31]
    ds_read_b64_tr_b16 v[36:37], v12 offset:25600
    ds_read_b64_tr_b16 v[38:39], v12 offset:25856
    s_waitcnt lgkmcnt(6)
    v_mfma_f32_32x32x16_bf16 v[16:31], v[40:43], v[216:219], v[16:31]
    ds_read_b64_tr_b16 v[40:41], v12 offset:26624
    ds_read_b64_tr_b16 v[42:43], v12 offset:26880
    s_waitcnt lgkmcnt(6)
    v_mfma_f32_32x32x16_bf16 v[16:31], v[44:47], v[220:223], v[16:31]
    ds_read_b64_tr_b16 v[44:45], v12 offset:27648
    ds_read_b64_tr_b16 v[46:47], v12 offset:27904
    s_waitcnt lgkmcnt(6)
    v_mfma_f32_32x32x16_bf16 v[16:31], v[32:35], v[224:227], v[16:31]
    ds_read_b64_tr_b16 v[32:33], v12 offset:28672
    ds_read_b64_tr_b16 v[34:35], v12 offset:28928
    s_waitcnt lgkmcnt(6)
    v_mfma_f32_32x32x16_bf16 v[16:31], v[36:39], v[228:231], v[16:31]
    ds_read_b64_tr_b16 v[36:37], v12 offset:29696
    ds_read_b64_tr_b16 v[38:39], v12 offset:29952
    s_waitcnt lgkmcnt(6)
    v_mfma_f32_32x32x16_bf16 v[16:31], v[40:43], v[232:235], v[16:31]
    ds_read_b64_tr_b16 v[40:41], v12 offset:30720
    ds_read_b64_tr_b16 v[42:43], v12 offset:30976
    s_waitcnt lgkmcnt(6)
    v_mfma_f32_32x32x16_bf16 v[16:31], v[44:47], v[236:239], v[16:31]
    ds_read_b64_tr_b16 v[44:45], v12 offset:31744
    ds_read_b64_tr_b16 v[46:47], v12 offset:32000
    s_waitcnt lgkmcnt(6)
    v_mfma_f32_32x32x16_bf16 v[16:31], v[32:35], v[240:243], v[16:31]
    s_waitcnt lgkmcnt(4)
    v_mfma_f32_32x32x16_bf16 v[16:31], v[36:39], v[244:247], v[16:31]
    s_waitcnt lgkmcnt(2)
    v_mfma_f32_32x32x16_bf16 v[16:31], v[40:43], v[248:251], v[16:31]
    s_waitcnt lgkmcnt(0)
    v_mfma_f32_32x32x16_bf16 v[16:31], v[44:47], v[252:255], v[16:31]
    buffer_load_dwordx4 v[128:131], v14, s[20:23], 0 offen offset:1024
    buffer_load_dwordx4 v[132:135], v14, s[20:23], 0 offen offset:1056
    buffer_load_dwordx4 v[136:139], v14, s[20:23], 0 offen offset:1088
    buffer_load_dwordx4 v[140:143], v14, s[20:23], 0 offen offset:1120
    buffer_load_dwordx4 v[144:147], v14, s[20:23], 0 offen offset:1152
    buffer_load_dwordx4 v[148:151], v14, s[20:23], 0 offen offset:1184
    buffer_load_dwordx4 v[152:155], v14, s[20:23], 0 offen offset:1216
    buffer_load_dwordx4 v[156:159], v14, s[20:23], 0 offen offset:1248
    buffer_load_dwordx4 v[160:163], v14, s[20:23], 0 offen offset:1280
    buffer_load_dwordx4 v[164:167], v14, s[20:23], 0 offen offset:1312
    buffer_load_dwordx4 v[168:171], v14, s[20:23], 0 offen offset:1344
    buffer_load_dwordx4 v[172:175], v14, s[20:23], 0 offen offset:1376
    buffer_load_dwordx4 v[176:179], v14, s[20:23], 0 offen offset:1408
    buffer_load_dwordx4 v[180:183], v14, s[20:23], 0 offen offset:1440
    buffer_load_dwordx4 v[184:187], v14, s[20:23], 0 offen offset:1472
    buffer_load_dwordx4 v[188:191], v14, s[20:23], 0 offen offset:1504
    buffer_load_dwordx4 v[192:195], v14, s[20:23], 0 offen offset:1536
    buffer_load_dwordx4 v[196:199], v14, s[20:23], 0 offen offset:1568
    buffer_load_dwordx4 v[200:203], v14, s[20:23], 0 offen offset:1600
    buffer_load_dwordx4 v[204:207], v14, s[20:23], 0 offen offset:1632
    buffer_load_dwordx4 v[208:211], v14, s[20:23], 0 offen offset:1664
    buffer_load_dwordx4 v[212:215], v14, s[20:23], 0 offen offset:1696
    buffer_load_dwordx4 v[216:219], v14, s[20:23], 0 offen offset:1728
    buffer_load_dwordx4 v[220:223], v14, s[20:23], 0 offen offset:1760
    buffer_load_dwordx4 v[224:227], v14, s[20:23], 0 offen offset:1792
    buffer_load_dwordx4 v[228:231], v14, s[20:23], 0 offen offset:1824
    buffer_load_dwordx4 v[232:235], v14, s[20:23], 0 offen offset:1856
    buffer_load_dwordx4 v[236:239], v14, s[20:23], 0 offen offset:1888
    buffer_load_dwordx4 v[240:243], v14, s[20:23], 0 offen offset:1920
    buffer_load_dwordx4 v[244:247], v14, s[20:23], 0 offen offset:1952
    buffer_load_dwordx4 v[248:251], v14, s[20:23], 0 offen offset:1984
    buffer_load_dwordx4 v[252:255], v14, s[20:23], 0 offen offset:2016
    s_waitcnt vmcnt(0)
    ds_read_b64_tr_b16 v[32:33], v12 offset:32768
    ds_read_b64_tr_b16 v[34:35], v12 offset:33024
    ds_read_b64_tr_b16 v[36:37], v12 offset:33792
    ds_read_b64_tr_b16 v[38:39], v12 offset:34048
    ds_read_b64_tr_b16 v[40:41], v12 offset:34816
    ds_read_b64_tr_b16 v[42:43], v12 offset:35072
    ds_read_b64_tr_b16 v[44:45], v12 offset:35840
    ds_read_b64_tr_b16 v[46:47], v12 offset:36096
    s_waitcnt lgkmcnt(6)
    v_mfma_f32_32x32x16_bf16 v[16:31], v[32:35], v[128:131], v[16:31]
    ds_read_b64_tr_b16 v[32:33], v12 offset:36864
    ds_read_b64_tr_b16 v[34:35], v12 offset:37120
    s_waitcnt lgkmcnt(6)
    v_mfma_f32_32x32x16_bf16 v[16:31], v[36:39], v[132:135], v[16:31]
    ds_read_b64_tr_b16 v[36:37], v12 offset:37888
    ds_read_b64_tr_b16 v[38:39], v12 offset:38144
    s_waitcnt lgkmcnt(6)
    v_mfma_f32_32x32x16_bf16 v[16:31], v[40:43], v[136:139], v[16:31]
    ds_read_b64_tr_b16 v[40:41], v12 offset:38912
    ds_read_b64_tr_b16 v[42:43], v12 offset:39168
    s_waitcnt lgkmcnt(6)
    v_mfma_f32_32x32x16_bf16 v[16:31], v[44:47], v[140:143], v[16:31]
    ds_read_b64_tr_b16 v[44:45], v12 offset:39936
    ds_read_b64_tr_b16 v[46:47], v12 offset:40192
    s_waitcnt lgkmcnt(6)
    v_mfma_f32_32x32x16_bf16 v[16:31], v[32:35], v[144:147], v[16:31]
    ds_read_b64_tr_b16 v[32:33], v12 offset:40960
    ds_read_b64_tr_b16 v[34:35], v12 offset:41216
    s_waitcnt lgkmcnt(6)
    v_mfma_f32_32x32x16_bf16 v[16:31], v[36:39], v[148:151], v[16:31]
    ds_read_b64_tr_b16 v[36:37], v12 offset:41984
    ds_read_b64_tr_b16 v[38:39], v12 offset:42240
    s_waitcnt lgkmcnt(6)
    v_mfma_f32_32x32x16_bf16 v[16:31], v[40:43], v[152:155], v[16:31]
    ds_read_b64_tr_b16 v[40:41], v12 offset:43008
    ds_read_b64_tr_b16 v[42:43], v12 offset:43264
    s_waitcnt lgkmcnt(6)
    v_mfma_f32_32x32x16_bf16 v[16:31], v[44:47], v[156:159], v[16:31]
    ds_read_b64_tr_b16 v[44:45], v12 offset:44032
    ds_read_b64_tr_b16 v[46:47], v12 offset:44288
    s_waitcnt lgkmcnt(6)
    v_mfma_f32_32x32x16_bf16 v[16:31], v[32:35], v[160:163], v[16:31]
    ds_read_b64_tr_b16 v[32:33], v12 offset:45056
    ds_read_b64_tr_b16 v[34:35], v12 offset:45312
    s_waitcnt lgkmcnt(6)
    v_mfma_f32_32x32x16_bf16 v[16:31], v[36:39], v[164:167], v[16:31]
    ds_read_b64_tr_b16 v[36:37], v12 offset:46080
    ds_read_b64_tr_b16 v[38:39], v12 offset:46336
    s_waitcnt lgkmcnt(6)
    v_mfma_f32_32x32x16_bf16 v[16:31], v[40:43], v[168:171], v[16:31]
    ds_read_b64_tr_b16 v[40:41], v12 offset:47104
    ds_read_b64_tr_b16 v[42:43], v12 offset:47360
    s_waitcnt lgkmcnt(6)
    v_mfma_f32_32x32x16_bf16 v[16:31], v[44:47], v[172:175], v[16:31]
    ds_read_b64_tr_b16 v[44:45], v12 offset:48128
    ds_read_b64_tr_b16 v[46:47], v12 offset:48384
    s_waitcnt lgkmcnt(6)
    v_mfma_f32_32x32x16_bf16 v[16:31], v[32:35], v[176:179], v[16:31]
    ds_read_b64_tr_b16 v[32:33], v12 offset:49152
    ds_read_b64_tr_b16 v[34:35], v12 offset:49408
    s_waitcnt lgkmcnt(6)
    v_mfma_f32_32x32x16_bf16 v[16:31], v[36:39], v[180:183], v[16:31]
    ds_read_b64_tr_b16 v[36:37], v12 offset:50176
    ds_read_b64_tr_b16 v[38:39], v12 offset:50432
    s_waitcnt lgkmcnt(6)
    v_mfma_f32_32x32x16_bf16 v[16:31], v[40:43], v[184:187], v[16:31]
    ds_read_b64_tr_b16 v[40:41], v12 offset:51200
    ds_read_b64_tr_b16 v[42:43], v12 offset:51456
    s_waitcnt lgkmcnt(6)
    v_mfma_f32_32x32x16_bf16 v[16:31], v[44:47], v[188:191], v[16:31]
    ds_read_b64_tr_b16 v[44:45], v12 offset:52224
    ds_read_b64_tr_b16 v[46:47], v12 offset:52480
    s_waitcnt lgkmcnt(6)
    v_mfma_f32_32x32x16_bf16 v[16:31], v[32:35], v[192:195], v[16:31]
    ds_read_b64_tr_b16 v[32:33], v12 offset:53248
    ds_read_b64_tr_b16 v[34:35], v12 offset:53504
    s_waitcnt lgkmcnt(6)
    v_mfma_f32_32x32x16_bf16 v[16:31], v[36:39], v[196:199], v[16:31]
    ds_read_b64_tr_b16 v[36:37], v12 offset:54272
    ds_read_b64_tr_b16 v[38:39], v12 offset:54528
    s_waitcnt lgkmcnt(6)
    v_mfma_f32_32x32x16_bf16 v[16:31], v[40:43], v[200:203], v[16:31]
    ds_read_b64_tr_b16 v[40:41], v12 offset:55296
    ds_read_b64_tr_b16 v[42:43], v12 offset:55552
    s_waitcnt lgkmcnt(6)
    v_mfma_f32_32x32x16_bf16 v[16:31], v[44:47], v[204:207], v[16:31]
    ds_read_b64_tr_b16 v[44:45], v12 offset:56320
    ds_read_b64_tr_b16 v[46:47], v12 offset:56576
    s_waitcnt lgkmcnt(6)
    v_mfma_f32_32x32x16_bf16 v[16:31], v[32:35], v[208:211], v[16:31]
    ds_read_b64_tr_b16 v[32:33], v12 offset:57344
    ds_read_b64_tr_b16 v[34:35], v12 offset:57600
    s_waitcnt lgkmcnt(6)
    v_mfma_f32_32x32x16_bf16 v[16:31], v[36:39], v[212:215], v[16:31]
    ds_read_b64_tr_b16 v[36:37], v12 offset:58368
    ds_read_b64_tr_b16 v[38:39], v12 offset:58624
    s_waitcnt lgkmcnt(6)
    v_mfma_f32_32x32x16_bf16 v[16:31], v[40:43], v[216:219], v[16:31]
    ds_read_b64_tr_b16 v[40:41], v12 offset:59392
    ds_read_b64_tr_b16 v[42:43], v12 offset:59648
    s_waitcnt lgkmcnt(6)
    v_mfma_f32_32x32x16_bf16 v[16:31], v[44:47], v[220:223], v[16:31]
    ds_read_b64_tr_b16 v[44:45], v12 offset:60416
    ds_read_b64_tr_b16 v[46:47], v12 offset:60672
    s_waitcnt lgkmcnt(6)
    v_mfma_f32_32x32x16_bf16 v[16:31], v[32:35], v[224:227], v[16:31]
    ds_read_b64_tr_b16 v[32:33], v12 offset:61440
    ds_read_b64_tr_b16 v[34:35], v12 offset:61696
    s_waitcnt lgkmcnt(6)
    v_mfma_f32_32x32x16_bf16 v[16:31], v[36:39], v[228:231], v[16:31]
    ds_read_b64_tr_b16 v[36:37], v12 offset:62464
    ds_read_b64_tr_b16 v[38:39], v12 offset:62720
    s_waitcnt lgkmcnt(6)
    v_mfma_f32_32x32x16_bf16 v[16:31], v[40:43], v[232:235], v[16:31]
    ds_read_b64_tr_b16 v[40:41], v12 offset:63488
    ds_read_b64_tr_b16 v[42:43], v12 offset:63744
    s_waitcnt lgkmcnt(6)
    v_mfma_f32_32x32x16_bf16 v[16:31], v[44:47], v[236:239], v[16:31]
    ds_read_b64_tr_b16 v[44:45], v12 offset:64512
    ds_read_b64_tr_b16 v[46:47], v12 offset:64768
    s_waitcnt lgkmcnt(6)
    v_mfma_f32_32x32x16_bf16 v[16:31], v[32:35], v[240:243], v[16:31]
    s_waitcnt lgkmcnt(4)
    v_mfma_f32_32x32x16_bf16 v[16:31], v[36:39], v[244:247], v[16:31]
    s_waitcnt lgkmcnt(2)
    v_mfma_f32_32x32x16_bf16 v[16:31], v[40:43], v[248:251], v[16:31]
    s_waitcnt lgkmcnt(0)
    v_mfma_f32_32x32x16_bf16 v[16:31], v[44:47], v[252:255], v[16:31]
    buffer_load_dwordx4 v[128:131], v14, s[20:23], 0 offen offset:2048
    buffer_load_dwordx4 v[132:135], v14, s[20:23], 0 offen offset:2080
    buffer_load_dwordx4 v[136:139], v14, s[20:23], 0 offen offset:2112
    buffer_load_dwordx4 v[140:143], v14, s[20:23], 0 offen offset:2144
    buffer_load_dwordx4 v[144:147], v14, s[20:23], 0 offen offset:2176
    buffer_load_dwordx4 v[148:151], v14, s[20:23], 0 offen offset:2208
    buffer_load_dwordx4 v[152:155], v14, s[20:23], 0 offen offset:2240
    buffer_load_dwordx4 v[156:159], v14, s[20:23], 0 offen offset:2272
    buffer_load_dwordx4 v[160:163], v14, s[20:23], 0 offen offset:2304
    buffer_load_dwordx4 v[164:167], v14, s[20:23], 0 offen offset:2336
    buffer_load_dwordx4 v[168:171], v14, s[20:23], 0 offen offset:2368
    buffer_load_dwordx4 v[172:175], v14, s[20:23], 0 offen offset:2400
    buffer_load_dwordx4 v[176:179], v14, s[20:23], 0 offen offset:2432
    buffer_load_dwordx4 v[180:183], v14, s[20:23], 0 offen offset:2464
    buffer_load_dwordx4 v[184:187], v14, s[20:23], 0 offen offset:2496
    buffer_load_dwordx4 v[188:191], v14, s[20:23], 0 offen offset:2528
    buffer_load_dwordx4 v[192:195], v14, s[20:23], 0 offen offset:2560
    buffer_load_dwordx4 v[196:199], v14, s[20:23], 0 offen offset:2592
    buffer_load_dwordx4 v[200:203], v14, s[20:23], 0 offen offset:2624
    buffer_load_dwordx4 v[204:207], v14, s[20:23], 0 offen offset:2656
    buffer_load_dwordx4 v[208:211], v14, s[20:23], 0 offen offset:2688
    buffer_load_dwordx4 v[212:215], v14, s[20:23], 0 offen offset:2720
    s_waitcnt vmcnt(0)
    ds_read_b64_tr_b16 v[32:33], v13 offset:0
    ds_read_b64_tr_b16 v[34:35], v13 offset:256
    ds_read_b64_tr_b16 v[36:37], v13 offset:1024
    ds_read_b64_tr_b16 v[38:39], v13 offset:1280
    ds_read_b64_tr_b16 v[40:41], v13 offset:2048
    ds_read_b64_tr_b16 v[42:43], v13 offset:2304
    ds_read_b64_tr_b16 v[44:45], v13 offset:3072
    ds_read_b64_tr_b16 v[46:47], v13 offset:3328
    s_waitcnt lgkmcnt(6)
    v_mfma_f32_32x32x16_bf16 v[16:31], v[32:35], v[128:131], v[16:31]
    ds_read_b64_tr_b16 v[32:33], v13 offset:4096
    ds_read_b64_tr_b16 v[34:35], v13 offset:4352
    s_waitcnt lgkmcnt(6)
    v_mfma_f32_32x32x16_bf16 v[16:31], v[36:39], v[132:135], v[16:31]
    ds_read_b64_tr_b16 v[36:37], v13 offset:5120
    ds_read_b64_tr_b16 v[38:39], v13 offset:5376
    s_waitcnt lgkmcnt(6)
    v_mfma_f32_32x32x16_bf16 v[16:31], v[40:43], v[136:139], v[16:31]
    ds_read_b64_tr_b16 v[40:41], v13 offset:6144
    ds_read_b64_tr_b16 v[42:43], v13 offset:6400
    s_waitcnt lgkmcnt(6)
    v_mfma_f32_32x32x16_bf16 v[16:31], v[44:47], v[140:143], v[16:31]
    ds_read_b64_tr_b16 v[44:45], v13 offset:7168
    ds_read_b64_tr_b16 v[46:47], v13 offset:7424
    s_waitcnt lgkmcnt(6)
    v_mfma_f32_32x32x16_bf16 v[16:31], v[32:35], v[144:147], v[16:31]
    ds_read_b64_tr_b16 v[32:33], v13 offset:8192
    ds_read_b64_tr_b16 v[34:35], v13 offset:8448
    s_waitcnt lgkmcnt(6)
    v_mfma_f32_32x32x16_bf16 v[16:31], v[36:39], v[148:151], v[16:31]
    ds_read_b64_tr_b16 v[36:37], v13 offset:9216
    ds_read_b64_tr_b16 v[38:39], v13 offset:9472
    s_waitcnt lgkmcnt(6)
    v_mfma_f32_32x32x16_bf16 v[16:31], v[40:43], v[152:155], v[16:31]
    ds_read_b64_tr_b16 v[40:41], v13 offset:10240
    ds_read_b64_tr_b16 v[42:43], v13 offset:10496
    s_waitcnt lgkmcnt(6)
    v_mfma_f32_32x32x16_bf16 v[16:31], v[44:47], v[156:159], v[16:31]
    ds_read_b64_tr_b16 v[44:45], v13 offset:11264
    ds_read_b64_tr_b16 v[46:47], v13 offset:11520
    s_waitcnt lgkmcnt(6)
    v_mfma_f32_32x32x16_bf16 v[16:31], v[32:35], v[160:163], v[16:31]
    ds_read_b64_tr_b16 v[32:33], v13 offset:12288
    ds_read_b64_tr_b16 v[34:35], v13 offset:12544
    s_waitcnt lgkmcnt(6)
    v_mfma_f32_32x32x16_bf16 v[16:31], v[36:39], v[164:167], v[16:31]
    ds_read_b64_tr_b16 v[36:37], v13 offset:13312
    ds_read_b64_tr_b16 v[38:39], v13 offset:13568
    s_waitcnt lgkmcnt(6)
    v_mfma_f32_32x32x16_bf16 v[16:31], v[40:43], v[168:171], v[16:31]
    ds_read_b64_tr_b16 v[40:41], v13 offset:14336
    ds_read_b64_tr_b16 v[42:43], v13 offset:14592
    s_waitcnt lgkmcnt(6)
    v_mfma_f32_32x32x16_bf16 v[16:31], v[44:47], v[172:175], v[16:31]
    ds_read_b64_tr_b16 v[44:45], v13 offset:15360
    ds_read_b64_tr_b16 v[46:47], v13 offset:15616
    s_waitcnt lgkmcnt(6)
    v_mfma_f32_32x32x16_bf16 v[16:31], v[32:35], v[176:179], v[16:31]
    ds_read_b64_tr_b16 v[32:33], v13 offset:16384
    ds_read_b64_tr_b16 v[34:35], v13 offset:16640
    s_waitcnt lgkmcnt(6)
    v_mfma_f32_32x32x16_bf16 v[16:31], v[36:39], v[180:183], v[16:31]
    ds_read_b64_tr_b16 v[36:37], v13 offset:17408
    ds_read_b64_tr_b16 v[38:39], v13 offset:17664
    s_waitcnt lgkmcnt(6)
    v_mfma_f32_32x32x16_bf16 v[16:31], v[40:43], v[184:187], v[16:31]
    ds_read_b64_tr_b16 v[40:41], v13 offset:18432
    ds_read_b64_tr_b16 v[42:43], v13 offset:18688
    s_waitcnt lgkmcnt(6)
    v_mfma_f32_32x32x16_bf16 v[16:31], v[44:47], v[188:191], v[16:31]
    ds_read_b64_tr_b16 v[44:45], v13 offset:19456
    ds_read_b64_tr_b16 v[46:47], v13 offset:19712
    s_waitcnt lgkmcnt(6)
    v_mfma_f32_32x32x16_bf16 v[16:31], v[32:35], v[192:195], v[16:31]
    ds_read_b64_tr_b16 v[32:33], v13 offset:20480
    ds_read_b64_tr_b16 v[34:35], v13 offset:20736
    s_waitcnt lgkmcnt(6)
    v_mfma_f32_32x32x16_bf16 v[16:31], v[36:39], v[196:199], v[16:31]
    ds_read_b64_tr_b16 v[36:37], v13 offset:21504
    ds_read_b64_tr_b16 v[38:39], v13 offset:21760
    s_waitcnt lgkmcnt(6)
    v_mfma_f32_32x32x16_bf16 v[16:31], v[40:43], v[200:203], v[16:31]
    s_waitcnt lgkmcnt(4)
    v_mfma_f32_32x32x16_bf16 v[16:31], v[44:47], v[204:207], v[16:31]
    s_waitcnt lgkmcnt(2)
    v_mfma_f32_32x32x16_bf16 v[16:31], v[32:35], v[208:211], v[16:31]
    s_waitcnt lgkmcnt(0)
    v_mfma_f32_32x32x16_bf16 v[16:31], v[36:39], v[212:215], v[16:31]
    v_lshlrev_b32 v6, 10, v10
    v_lshl_add_u32 v6, v11, 3, v6
    s_lshl_b32 s7, s5, 6
    v_add_u32 v6, s7, v6
    v_add_u32 v7, 0x500000, v6
    buffer_load_dwordx2 v[32:33], v7, s[20:23], 0 offen offset:0
    buffer_load_dwordx2 v[34:35], v7, s[20:23], 0 offen offset:16
    buffer_load_dwordx2 v[36:37], v7, s[20:23], 0 offen offset:32
    buffer_load_dwordx2 v[38:39], v7, s[20:23], 0 offen offset:48
    s_waitcnt vmcnt(3)
    v_lshlrev_b32 v2, 16, v32
    s_nop 0
    v_add_f32 v16, v2, v16
    v_and_b32 v2, 0xffff0000, v32
    v_add_f32 v17, v2, v17
    v_lshlrev_b32 v2, 16, v33
    v_add_f32 v18, v2, v18
    v_and_b32 v2, 0xffff0000, v33
    v_add_f32 v19, v2, v19
    v_cvt_pk_bf16_f32 v2, v16, v17
    v_cvt_pk_bf16_f32 v3, v18, v19
    buffer_store_dwordx2 v[2:3], v6, s[16:19], 0 offen offset:0
    s_nop 1
    s_waitcnt vmcnt(2)
    v_lshlrev_b32 v2, 16, v34
    v_add_f32 v20, v2, v20
    v_and_b32 v2, 0xffff0000, v34
    v_add_f32 v21, v2, v21
    v_lshlrev_b32 v2, 16, v35
    v_add_f32 v22, v2, v22
    v_and_b32 v2, 0xffff0000, v35
    v_add_f32 v23, v2, v23
    v_cvt_pk_bf16_f32 v2, v20, v21
    v_cvt_pk_bf16_f32 v3, v22, v23
    buffer_store_dwordx2 v[2:3], v6, s[16:19], 0 offen offset:16
    s_nop 1
    s_waitcnt vmcnt(1)
    v_lshlrev_b32 v2, 16, v36
    v_add_f32 v24, v2, v24
    v_and_b32 v2, 0xffff0000, v36
    v_add_f32 v25, v2, v25
    v_lshlrev_b32 v2, 16, v37
    v_add_f32 v26, v2, v26
    v_and_b32 v2, 0xffff0000, v37
    v_add_f32 v27, v2, v27
    v_cvt_pk_bf16_f32 v2, v24, v25
    v_cvt_pk_bf16_f32 v3, v26, v27
    buffer_store_dwordx2 v[2:3], v6, s[16:19], 0 offen offset:32
    s_nop 1
    s_waitcnt vmcnt(0)
    v_lshlrev_b32 v2, 16, v38
    v_add_f32 v28, v2, v28
    v_and_b32 v2, 0xffff0000, v38
    v_add_f32 v29, v2, v29
    v_lshlrev_b32 v2, 16, v39
    v_add_f32 v30, v2, v30
    v_and_b32 v2, 0xffff0000, v39
    v_add_f32 v31, v2, v31
    v_cvt_pk_bf16_f32 v2, v28, v29
    v_cvt_pk_bf16_f32 v3, v30, v31
    buffer_store_dwordx2 v[2:3], v6, s[16:19], 0 offen offset:48
    s_nop 1
    s_nop 3
L5_end:
    s_endpgm
.section .rodata,"a"
.p2align 6
.amdhsa_kernel k1_kernel
  .amdhsa_next_free_vgpr 256
  .amdhsa_next_free_sgpr 102
  .amdhsa_accum_offset 256
  .amdhsa_group_segment_fixed_size 0
  .amdhsa_kernarg_size 96
  .amdhsa_user_sgpr_count 2
  .amdhsa_user_sgpr_kernarg_segment_ptr 1
  .amdhsa_system_sgpr_workgroup_id_x 1
.end_amdhsa_kernel
.amdhsa_kernel k2_kernel
  .amdhsa_next_free_vgpr 144
  .amdhsa_next_free_sgpr 102
  .amdhsa_accum_offset 144
  .amdhsa_group_segment_fixed_size 0
  .amdhsa_kernarg_size 96
  .amdhsa_user_sgpr_count 2
  .amdhsa_user_sgpr_kernarg_segment_ptr 1
  .amdhsa_system_sgpr_workgroup_id_x 1
.end_amdhsa_kernel
.amdhsa_kernel k3_kernel
  .amdhsa_next_free_vgpr 256
  .amdhsa_next_free_sgpr 102
  .amdhsa_accum_offset 256
  .amdhsa_group_segment_fixed_size 0
  .amdhsa_kernarg_size 96
  .amdhsa_user_sgpr_count 2
  .amdhsa_user_sgpr_kernarg_segment_ptr 1
  .amdhsa_system_sgpr_workgroup_id_x 1
.end_amdhsa_kernel
.amdhsa_kernel k4_kernel
  .amdhsa_next_free_vgpr 256
  .amdhsa_next_free_sgpr 102
  .amdhsa_accum_offset 256
  .amdhsa_group_segment_fixed_size 0
  .amdhsa_kernarg_size 96
  .amdhsa_user_sgpr_count 2
  .amdhsa_user_sgpr_kernarg_segment_ptr 1
  .amdhsa_system_sgpr_workgroup_id_x 1
.end_amdhsa_kernel
.amdhsa_kernel k5_kernel
  .amdhsa_next_free_vgpr 256
  .amdhsa_next_free_sgpr 102
  .amdhsa_accum_offset 256
  .amdhsa_group_segment_fixed_size 0
  .amdhsa_kernarg_size 96
  .amdhsa_user_sgpr_count 2
  .amdhsa_user_sgpr_kernarg_segment_ptr 1
  .amdhsa_system_sgpr_workgroup_id_x 1
.end_amdhsa_kernel
```
